```python
import torch

def _softmax(x, axis=-1):
    return torch.softmax(x, dim=axis)
def _gelu(x):
    return torch.nn.functional.gelu(x, approximate="tanh")
def _silu(x):
    return torch.nn.functional.silu(x)
def _sigmoid(x):
    return torch.sigmoid(x)
def _layernorm(x, axis=-1, eps=1e-5):
    m = x.mean(dim=axis, keepdim=True)
    v = x.var(dim=axis, keepdim=True, unbiased=False)
    return (x - m) / torch.sqrt(v + eps)
def _scatter_add(tgt, idx, src, axis=0):
    return tgt.clone().index_add_(axis, idx, src)
def _segment_sum(src, seg, n):
    out = torch.zeros((n,) + src.shape[1:], dtype=src.dtype)
    return out.index_add_(0, seg, src)
def _pad(x, pw):
    flat = tuple(v for pair in reversed(pw) for v in pair)
    return torch.nn.functional.pad(x, flat)

kernel_name = 'recurrent_scan__sliding_block__dense_activation_silu__prompt'

def setup_inputs():

    _w = (lambda a: (lambda t: t.to(torch.bfloat16) if t.is_floating_point() else t)(torch.as_tensor(a)))
    def _A_setup():
        B, S, D = 1, 2048, 448
        return {
            "x": _w((lambda *s: torch.randn(*s, dtype=torch.bfloat16) * 0.05)(B, S, D)),
            "wqkv": _w((lambda *s: torch.randn(*s, dtype=torch.bfloat16) * 0.2)(D, 3 * D)),
            "wo": _w((lambda *s: torch.randn(*s, dtype=torch.bfloat16) * 0.2)(D, D)),
        }
    _A_in = _A_setup()

    def _B_setup():
        B, S, D, F = 1, 2048, 448, 1792
        return {
            "x": _w((lambda *s: torch.randn(*s, dtype=torch.bfloat16) * 0.05)(B, S, D)),
            "w1": _w((lambda *s: torch.randn(*s, dtype=torch.bfloat16) * 3.2)(D, F) * (D ** -0.5)),
            "w2": _w((lambda *s: torch.randn(*s, dtype=torch.bfloat16) * 0.2)(F, D) * (F ** -0.5)),
        }
    _B_in = _B_setup()

    return {
        "A_x": _A_in["x"],
        "A_wqkv": _A_in["wqkv"],
        "A_wo": _A_in["wo"],
        "B_x": _B_in["x"],
        "B_w1": _B_in["w1"],
        "B_w2": _B_in["w2"],
    }

def reference(A_x, A_wqkv, A_wo, B_x, B_w1, B_w2):
    def _A_ref(x, wqkv, wo):
        B, S, D = x.shape
        H = 16; Dh = D // H; W = 256
        qkv = (lambda x, *d: x.permute(*d))((x @ wqkv).reshape(B, S, 3, H, Dh), 2, 0, 3, 1, 4)
        q, k, v = qkv[0], qkv[1], qkv[2]
        scores = torch.einsum("bhqd,bhkd->bhqk", q, k) * (Dh ** -0.5)
        idx = torch.arange(S)
        mask = (idx[:, None] - idx[None, :] >= 0) & (idx[:, None] - idx[None, :] < W)
        scores = torch.where(mask[None, None], scores, -1e9)
        p = _softmax(scores, axis=-1)
        o = torch.einsum("bhqk,bhkd->bhqd", p, v)
        return (lambda x, *d: x.permute(*d))(o, 0, 2, 1, 3).reshape(B, S, D) @ wo

    def _B_ref(x, w1, w2):
        h = torch.einsum("bsd,df->bsf", x, w1)
        h = _silu(h)
        out = torch.einsum("bsf,fd->bsd", h, w2)
        return out

    x = A_x
    xn = _layernorm(x, axis=-1)
    s = _A_ref(xn, A_wqkv, A_wo)
    g = _silu(_B_ref(xn, B_w1, B_w2))
    return x + s * g
```

```asm
; @launch grid=(256,1,1) block=(512,1,1) lds=163840
.amdgcn_target "amdgcn-amd-amdhsa--gfx950"
.text
.globl recurrent_scan__sliding_block__dense_activation_silu__prompt_kernel
.p2align 12
.p2align 8
.type recurrent_scan__sliding_block__dense_activation_silu__prompt_kernel,@function
recurrent_scan__sliding_block__dense_activation_silu__prompt_kernel:
    s_load_dwordx2 s[8:9], s[0:1], 0
    s_load_dwordx2 s[36:37], s[0:1], 64
    s_load_dwordx2 s[12:13], s[0:1], 8
    s_load_dwordx2 s[16:17], s[0:1], 16
    s_load_dwordx2 s[20:21], s[0:1], 32
    s_load_dwordx2 s[24:25], s[0:1], 40
    s_load_dwordx2 s[28:29], s[0:1], 48
    s_load_dwordx2 s[32:33], s[0:1], 56
    s_mov_b32 s11, 0x00020000
    s_cmp_ge_u32 s2, 32
    s_cbranch_scc1 L_nopf
    s_getpc_b64 s[4:5]
    s_mov_b32 s6, 0x7190
    s_mov_b32 s7, s11
    v_lshlrev_b32 v1, 7, v0
    buffer_load_dword v2, v1, s[4:7], 0 offen
L_nopf:
    v_lshrrev_b32 v1, 6, v0
    s_lshr_b32 s43, s2, 3
    s_and_b32 s42, s2, 7
    v_readfirstlane_b32 s40, v1
    s_mov_b32 s10, 1835008
    s_cmp_ge_u32 s43, 32
    s_cbranch_scc1 L_end
    s_sub_u32 s54, s43, 4
    s_cmp_ge_u32 s54, 28
    s_cbranch_scc1 L_other
    s_mul_i32 s50, s54, 37
    s_lshr_b32 s50, s50, 8
    s_mul_i32 s56, s50, 7
    s_sub_u32 s47, s54, s56
    s_and_b32 s44, s42, 6
    s_lshl1_add_u32 s44, s44, s50
    s_and_b32 s45, s42, 1
    s_mul_i32 s45, s45, 7
    s_add_u32 s45, s45, s47
    s_cmp_lt_u32 s40, 4
    s_cbranch_scc1 L_roleA
    s_and_b32 s59, s44, 1
    s_mul_i32 s59, s59, 3
    s_add_u32 s59, s59, s47
    s_mul_i32 s55, s59, 37
    s_lshr_b32 s55, s55, 8
    s_mul_i32 s55, s55, 7
    s_sub_u32 s59, s59, s55
    v_bfe_u32 v216, v0, 3, 5
    v_and_b32 v217, 7, v216
    v_and_b32 v216, 24, v216
    v_lshl_add_u32 v216, v216, 2, v217
    v_lshrrev_b32 v217, 1, v217
    v_xor_b32 v217, v217, v0
    v_and_b32 v217, 7, v217
    v_mul_u32_u24 v216, 56, v216
    v_add_lshl_u32 v152, v216, v217, 4
    s_and_b32 s41, s40, 3
    v_xor_b32 v153, 64, v152
    s_mul_i32 s61, s44, 896
    s_lshl_b32 s56, s41, 12
    v_add_u32 v153, 6144, v153
    s_waitcnt lgkmcnt(0)
    s_add_u32 m0, s56, 0
    s_add_u32 s62, s61, s59
    s_lshl_b32 s62, s62, 7
    s_add_u32 s63, s62, 12288
    buffer_load_dwordx4 v152, s[8:11], s62 offen offset:0 lds
    buffer_load_dwordx4 v153, s[8:11], s62 offen offset:1024 lds
    buffer_load_dwordx4 v152, s[8:11], s63 offen offset:2048 lds
    buffer_load_dwordx4 v153, s[8:11], s63 offen offset:3072 lds
    v_and_b32 v0, 63, v0
    s_and_b32 s41, s40, 3
    s_mov_b32 s51, 0
    s_mov_b32 s14, 1204224
    s_mov_b32 s15, s11
    s_lshl2_add_u32 s46, s42, s50
    s_mul_i32 s54, s41, 43008
    s_mul_i32 s55, s45, 192
    s_add_u32 s54, s54, s55
    s_mul_i32 s57, s41, 3072
    s_add_u32 s57, s57, 65536
    v_add_u32 v216, 0, v0
    v_mul_u32_u24 v217, 5462, v216
    v_lshrrev_b32 v217, 16, v217
    v_mul_u32_u24 v217, 2496, v217
    v_lshl_add_u32 v217, v0, 4, v217
    v_add_u32 v156, s54, v217
    v_add_u32 v216, 64, v0
    v_mul_u32_u24 v217, 5462, v216
    v_lshrrev_b32 v217, 16, v217
    v_mul_u32_u24 v217, 2496, v217
    v_lshl_add_u32 v217, v0, 4, v217
    v_add_u32 v157, s54, v217
    v_add_u32 v216, 128, v0
    v_mul_u32_u24 v217, 5462, v216
    v_lshrrev_b32 v217, 16, v217
    v_mul_u32_u24 v217, 2496, v217
    v_lshl_add_u32 v217, v0, 4, v217
    v_add_u32 v158, s54, v217
    s_add_u32 m0, s57, 0
    s_mul_i32 s62, s59, 172032
    buffer_load_dwordx4 v156, s[12:15], s62 offen offset:0 lds
    buffer_load_dwordx4 v157, s[12:15], s62 offen offset:1024 lds
    buffer_load_dwordx4 v158, s[12:15], s62 offen offset:2048 lds
    s_add_u32 s59, s59, 1
    s_cmp_eq_u32 s59, 7
    s_cselect_b32 s59, 0, s59
    s_and_b32 s53, s43, 1
    s_lshl1_add_u32 s48, s42, s53
    s_lshr_b32 s49, s43, 1
    s_mul_i32 s52, s48, 7
    s_lshr_b32 s52, s52, 1
    s_mov_b32 s18, 401408
    s_mov_b32 s19, s11
    s_mov_b32 s22, 1605632
    s_mov_b32 s23, s11
    s_mov_b32 s26, 1605632
    s_mov_b32 s27, s11
    s_mov_b32 s30, 1835008
    s_mov_b32 s31, s11
    s_mov_b32 s34, 256
    s_mov_b32 s35, s11
    s_mov_b32 s38, 26214400
    s_mov_b32 s39, s11
    v_lshrrev_b32 v216, 1, v0
    v_mul_u32_u24 v216, 3584, v216
    v_and_b32 v217, 1, v0
    v_lshl_add_u32 v216, v217, 7, v216
    s_lshl2_add_u32 s54, s44, s41
    s_mul_i32 s54, s54, 25088
    s_lshl_b32 s60, s45, 8
    s_add_u32 s54, s54, s60
    v_add_u32 v215, s54, v216
    v_mov_b32 v216, 161792
    v_mov_b32 v217, 0
    ds_write_b32 v216, v217
    ds_write_b32 v216, v217 offset:4
    ds_write_b32 v216, v217 offset:8
    ds_write_b32 v216, v217 offset:12
    ds_write_b32 v216, v217 offset:20
    ds_write_b32 v216, v217 offset:24
    ds_write_b32 v216, v217 offset:28
    s_lshl_b32 s55, s41, 11
    s_mul_i32 s54, s41, 57344
    s_lshl_b32 s60, s45, 8
    s_add_u32 s54, s54, s60
    v_lshrrev_b32 v216, 3, v0
    v_mul_u32_u24 v216, 3584, v216
    v_and_b32 v217, 7, v0
    v_bfe_u32 v218, v0, 4, 1
    v_lshlrev_b32 v218, 2, v218
    v_xor_b32 v217, v217, v218
    v_lshl_add_u32 v216, v217, 4, v216
    v_add_u32 v160, s54, v216
    v_add_u32 v161, 27648, v160
    v_lshrrev_b32 v216, 3, v0
    v_mul_u32_u24 v216, 896, v216
    v_and_b32 v217, 7, v0
    v_bfe_u32 v218, v0, 4, 1
    v_lshlrev_b32 v218, 2, v218
    v_xor_b32 v217, v217, v218
    v_lshl_add_u32 v2, v217, 4, v216
    v_add_u32 v3, 6144, v2
    v_lshrrev_b32 v216, 5, v0
    v_lshlrev_b32 v216, 3, v216
    v_bfe_u32 v218, v0, 2, 2
    v_add_u32 v216, v216, v218
    v_bfe_u32 v217, v0, 4, 1
    v_lshlrev_b32 v217, 5, v217
    v_and_b32 v219, 1, v0
    v_lshl_or_b32 v217, v219, 4, v217
    v_bfe_u32 v219, v0, 1, 1
    v_lshl_or_b32 v217, v219, 3, v217
    v_lshlrev_b32 v246, 7, v216
    v_add_u32 v246, v246, v217
    v_lshrrev_b32 v218, 1, v218
    v_lshl_or_b32 v246, v218, 6, v246
    v_add_u32 v246, s55, v246
    v_xor_b32 v247, 64, v246
    v_add_u32 v248, 0x10000, v246
    v_add_u32 v249, 0x10000, v247
    v_add_u32 v250, 0x20000, v246
    v_add_u32 v251, 0x20000, v247
    v_add_u32 v246, s56, v246
    v_add_u32 v247, s56, v247
    s_min_u32 s54, s41, 2
    s_lshl_b32 s54, s54, 6
    s_add_u32 s54, s54, 65536
    v_mul_u32_u24 v164, 192, v216
    v_add_u32 v164, v164, v217
    v_add_u32 v164, s54, v164
    v_lshlrev_b32 v165, 7, v216
    v_add_u32 v165, v165, v217
    s_and_b32 s54, s41, 1
    v_xor_b32 v218, s54, v218
    v_lshl_or_b32 v165, v218, 6, v165
    s_lshr_b32 s54, s41, 1
    s_lshl_b32 s54, s54, 12
    v_add_u32 v165, s54, v165
    v_add_u32 v162, 65536, v165
    v_add_u32 v163, 0x20000, v165
    s_lshl_b32 s54, s41, 9
    s_add_u32 s54, s54, 155648
    v_lshlrev_b32 v166, 3, v0
    v_add_u32 v166, s54, v166
    s_and_b32 s54, s41, 1
    s_lshl_b32 s54, s54, 10
    s_lshr_b32 s60, s41, 1
    s_lshl_b32 s60, s60, 3
    s_add_u32 s54, s54, s60
    s_add_u32 s54, s54, 157696
    v_lshlrev_b32 v167, 4, v0
    v_add_u32 v167, s54, v167
    s_mul_i32 s87, s41, 14336
    s_lshl_b32 s54, s47, 7
    s_add_u32 s87, s87, s54
    s_mul_i32 s94, s47, 0
    s_mul_i32 s54, s50, 0
    s_add_u32 s94, s94, s54
    s_min_u32 s54, s42, 6
    s_mul_i32 s54, s54, 0
    s_add_u32 s94, s94, s54
    s_cmp_ge_u32 s94, 14
    s_cselect_b32 s54, 14, 0
    s_sub_u32 s94, s94, s54
    s_mov_b32 s95, s94
    s_lshl_b32 s54, s49, 2
    s_mul_i32 s90, s41, 3
    s_add_u32 s90, s90, s54
    s_add_u32 s91, s54, s41
    v_lshlrev_b32 v204, 4, v0
    s_lshl_b32 s54, s52, 9
    s_mul_i32 s89, s41, 6144
    s_lshl_b32 s88, s41, 11
    s_add_u32 s60, s90, 0
    s_max_u32 s60, s60, 8
    s_sub_u32 s60, s60, 8
    s_mul_i32 s60, s60, 86016
    s_add_u32 s60, s60, s54
    s_add_u32 s80, s60, 28672
    s_add_u32 s81, s60, 57344
    s_add_u32 s60, s90, 1
    s_max_u32 s60, s60, 8
    s_sub_u32 s60, s60, 8
    s_mul_i32 s60, s60, 86016
    s_add_u32 s60, s60, s54
    s_add_u32 s82, s60, 28672
    s_add_u32 s83, s60, 57344
    s_add_u32 s60, s90, 2
    s_max_u32 s60, s60, 8
    s_sub_u32 s60, s60, 8
    s_mul_i32 s60, s60, 86016
    s_add_u32 s60, s60, s54
    s_add_u32 s84, s60, 28672
    s_add_u32 s85, s60, 57344
    s_mul_i32 s86, s91, 86016
    s_add_u32 s86, s86, s54
    s_lshl_b32 s92, s49, 4
    s_add_u32 s92, s92, s48
    s_mul_i32 s92, s92, 4352
    s_add_u32 s92, s92, 16777216
    s_cmp_eq_u32 s53, 1
    s_cselect_b32 s60, 0, 3
    s_cselect_b32 s62, 0, 1544
    s_add_u32 s60, s60, s52
    s_and_b32 s60, s60, 3
    s_lshl_b32 s60, s60, 6
    v_and_b32 v184, 31, v0
    v_lshlrev_b32 v184, 4, v184
    v_xor_b32 v184, s60, v184
    v_add_u32 v186, s62, v184
    v_cmp_lt_u32 vcc, 31, v0
    s_add_u32 s60, s89, 4096
    s_add_u32 s62, s88, 49152
    v_mov_b32 v184, s60
    v_mov_b32 v185, s62
    v_cndmask_b32 v185, v184, v185, vcc
    v_add_u32 v185, v185, v186
    v_add_u32 v187, v184, v186
    v_lshrrev_b32 v184, 5, v0
    v_lshl_add_u32 v184, v184, 11, v186
    v_add_u32 v184, s89, v184
    v_mov_b32 v188, 0x3f80
    v_mov_b32 v189, 0
    v_mov_b32 v191, 0
    v_mov_b32 v193, 0
    s_cmp_lt_u32 s90, 8
    s_cselect_b32 s60, 0xf14a, 0
    v_mov_b32 v190, s60
    s_cmp_lt_u32 s90, 7
    s_cselect_b32 s60, 0xf14a, 0
    v_mov_b32 v192, s60
    v_cndmask_b32 v190, v190, v192, vcc
    s_cmp_lt_u32 s90, 6
    s_cselect_b32 s60, 0xf14a, 0
    v_mov_b32 v192, s60
    v_cndmask_b32 v192, v192, v188, vcc
    v_lshlrev_b32 v252, 4, v0
    v_add_u32 v253, 114688, v252
    v_mov_b32 v212, 161796
    v_mov_b32 v213, 1
    s_add_u32 s54, s55, 65536
    v_and_b32 v4, 31, v0
    v_lshrrev_b32 v5, 5, v0
    v_lshlrev_b32 v6, 1, v5
    v_xor_b32 v4, v4, v6
    v_lshlrev_b32 v4, 4, v4
    v_lshl_or_b32 v4, v5, 10, v4
    v_add_u32 v4, s54, v4
    v_xor_b32 v5, 64, v4
    v_xor_b32 v6, 0x80, v4
    v_xor_b32 v7, 0xc0, v4
    s_lshl_b32 s60, s46, 3
    s_add_u32 s60, s60, s40
    s_mul_i32 s60, s60, 7168
    s_lshl_b32 s54, s47, 7
    s_add_u32 s60, s60, s54
    v_lshrrev_b32 v244, 3, v0
    v_mul_u32_u24 v244, 896, v244
    v_and_b32 v245, 7, v0
    v_lshl_add_u32 v244, v245, 4, v244
    v_add_u32 v244, s60, v244
    s_lshl2_add_u32 s54, s41, 161824
    v_mov_b32 v216, s54
    v_mov_b32 v217, 0
    ds_write_b32 v216, v217
    v_mov_b32 v245, 1
    v_mov_b32 v254, 161792
    v_lshrrev_b32 v216, 2, v0
    v_lshrrev_b32 v217, 4, v0
    v_xor_b32 v216, v216, v217
    v_and_b32 v216, 1, v216
    v_cmp_eq_u32 vcc, 0, v216
    v_mov_b32 v217, 0x3f803f80
    s_nop 0
    v_cndmask_b32 v208, 0, v217, vcc
    v_cmp_gt_u32 s[78:79], 32, v0
    v_mov_b32 v209, v208
    v_mov_b32 v210, v208
    v_mov_b32 v211, v208
    s_add_u32 m0, s56, 16384
    s_add_u32 s62, s61, s59
    s_lshl_b32 s62, s62, 7
    s_add_u32 s63, s62, 12288
    buffer_load_dwordx4 v152, s[8:11], s62 offen offset:0 lds
    buffer_load_dwordx4 v153, s[8:11], s62 offen offset:1024 lds
    buffer_load_dwordx4 v152, s[8:11], s63 offen offset:2048 lds
    buffer_load_dwordx4 v153, s[8:11], s63 offen offset:3072 lds
    s_add_u32 m0, s57, 12288
    s_mul_i32 s62, s59, 172032
    buffer_load_dwordx4 v156, s[12:15], s62 offen offset:0 lds
    buffer_load_dwordx4 v157, s[12:15], s62 offen offset:1024 lds
    buffer_load_dwordx4 v158, s[12:15], s62 offen offset:2048 lds
    s_add_u32 s59, s59, 1
    s_cmp_eq_u32 s59, 7
    s_cselect_b32 s59, 0, s59
    s_waitcnt vmcnt(7)
    s_waitcnt lgkmcnt(0)
    s_barrier
    s_add_u32 m0, s56, 32768
    s_add_u32 s62, s61, s59
    s_lshl_b32 s62, s62, 7
    s_add_u32 s63, s62, 12288
    buffer_load_dwordx4 v152, s[8:11], s62 offen offset:0 lds
    ds_read_b64_tr_b16 v[168:169], v164 offset:0
    ds_read_b64_tr_b16 v[170:171], v164 offset:768
    buffer_load_dwordx4 v153, s[8:11], s62 offen offset:1024 lds
    ds_read_b64_tr_b16 v[172:173], v164 offset:3072
    ds_read_b64_tr_b16 v[174:175], v164 offset:3840
    buffer_load_dwordx4 v152, s[8:11], s63 offen offset:2048 lds
    ds_read_b64_tr_b16 v[176:177], v164 offset:6144
    ds_read_b64_tr_b16 v[178:179], v164 offset:6912
    buffer_load_dwordx4 v153, s[8:11], s63 offen offset:3072 lds
    s_add_u32 m0, s57, 24576
    s_mul_i32 s62, s59, 172032
    buffer_load_dwordx4 v156, s[12:15], s62 offen offset:0 lds
    ds_read_b64_tr_b16 v[180:181], v164 offset:9216
    ds_read_b64_tr_b16 v[182:183], v164 offset:9984
    buffer_load_dwordx4 v157, s[12:15], s62 offen offset:1024 lds
    s_waitcnt lgkmcnt(0)
    s_setprio 1
    v_mfma_f32_16x16x32_bf16 v[200:203], v[208:211], v[168:171], 0
    v_mfma_f32_16x16x32_bf16 v[200:203], v[208:211], v[172:175], v[200:203]
    v_mfma_f32_16x16x32_bf16 v[200:203], v[208:211], v[176:179], v[200:203]
    v_mfma_f32_16x16x32_bf16 v[200:203], v[208:211], v[180:183], v[200:203]
    s_setprio 0
    buffer_load_dwordx4 v158, s[12:15], s62 offen offset:2048 lds
    s_add_u32 s59, s59, 1
    s_cmp_eq_u32 s59, 7
    s_cselect_b32 s59, 0, s59
    s_bfm_b64 exec, 14, 0
    buffer_load_dword v1, v215, s[20:23], 0 offen
    s_mov_b64 exec, -1
    s_waitcnt vmcnt(8)
    s_barrier
    s_add_u32 m0, s56, 49152
    s_add_u32 s62, s61, s59
    s_lshl_b32 s62, s62, 7
    s_add_u32 s63, s62, 12288
    buffer_load_dwordx4 v152, s[8:11], s62 offen offset:0 lds
    ds_read_b64_tr_b16 v[168:169], v164 offset:12288
    ds_read_b64_tr_b16 v[170:171], v164 offset:13056
    buffer_load_dwordx4 v153, s[8:11], s62 offen offset:1024 lds
    ds_read_b64_tr_b16 v[172:173], v164 offset:15360
    ds_read_b64_tr_b16 v[174:175], v164 offset:16128
    buffer_load_dwordx4 v152, s[8:11], s63 offen offset:2048 lds
    ds_read_b64_tr_b16 v[176:177], v164 offset:18432
    ds_read_b64_tr_b16 v[178:179], v164 offset:19200
    buffer_load_dwordx4 v153, s[8:11], s63 offen offset:3072 lds
    s_add_u32 m0, s57, 36864
    s_mul_i32 s62, s59, 172032
    buffer_load_dwordx4 v156, s[12:15], s62 offen offset:0 lds
    ds_read_b64_tr_b16 v[180:181], v164 offset:21504
    ds_read_b64_tr_b16 v[182:183], v164 offset:22272
    buffer_load_dwordx4 v157, s[12:15], s62 offen offset:1024 lds
    s_waitcnt lgkmcnt(0)
    s_setprio 1
    v_mfma_f32_16x16x32_bf16 v[200:203], v[208:211], v[168:171], v[200:203]
    v_mfma_f32_16x16x32_bf16 v[200:203], v[208:211], v[172:175], v[200:203]
    v_mfma_f32_16x16x32_bf16 v[200:203], v[208:211], v[176:179], v[200:203]
    v_mfma_f32_16x16x32_bf16 v[200:203], v[208:211], v[180:183], v[200:203]
    s_setprio 0
    buffer_load_dwordx4 v158, s[12:15], s62 offen offset:2048 lds
    s_add_u32 s59, s59, 1
    s_cmp_eq_u32 s59, 7
    s_cselect_b32 s59, 0, s59
    s_waitcnt vmcnt(8)
    s_barrier
    s_add_u32 m0, s56, 0
    s_add_u32 s62, s61, s59
    s_lshl_b32 s62, s62, 7
    s_add_u32 s63, s62, 12288
    buffer_load_dwordx4 v152, s[8:11], s62 offen offset:0 lds
    ds_read_b64_tr_b16 v[168:169], v164 offset:24576
    ds_read_b64_tr_b16 v[170:171], v164 offset:25344
    buffer_load_dwordx4 v153, s[8:11], s62 offen offset:1024 lds
    ds_read_b64_tr_b16 v[172:173], v164 offset:27648
    ds_read_b64_tr_b16 v[174:175], v164 offset:28416
    buffer_load_dwordx4 v152, s[8:11], s63 offen offset:2048 lds
    ds_read_b64_tr_b16 v[176:177], v164 offset:30720
    ds_read_b64_tr_b16 v[178:179], v164 offset:31488
    buffer_load_dwordx4 v153, s[8:11], s63 offen offset:3072 lds
    s_add_u32 m0, s57, 0
    s_mul_i32 s62, s59, 172032
    buffer_load_dwordx4 v156, s[12:15], s62 offen offset:0 lds
    ds_read_b64_tr_b16 v[180:181], v164 offset:33792
    ds_read_b64_tr_b16 v[182:183], v164 offset:34560
    buffer_load_dwordx4 v157, s[12:15], s62 offen offset:1024 lds
    s_waitcnt lgkmcnt(0)
    s_setprio 1
    v_mfma_f32_16x16x32_bf16 v[200:203], v[208:211], v[168:171], v[200:203]
    v_mfma_f32_16x16x32_bf16 v[200:203], v[208:211], v[172:175], v[200:203]
    v_mfma_f32_16x16x32_bf16 v[200:203], v[208:211], v[176:179], v[200:203]
    v_mfma_f32_16x16x32_bf16 v[200:203], v[208:211], v[180:183], v[200:203]
    s_setprio 0
    buffer_load_dwordx4 v158, s[12:15], s62 offen offset:2048 lds
    s_add_u32 s59, s59, 1
    s_cmp_eq_u32 s59, 7
    s_cselect_b32 s59, 0, s59
    s_waitcnt vmcnt(7)
    s_barrier
    ds_read_b64_tr_b16 v[168:169], v164 offset:36864
    ds_read_b64_tr_b16 v[170:171], v164 offset:37632
    ds_read_b64_tr_b16 v[172:173], v164 offset:39936
    ds_read_b64_tr_b16 v[174:175], v164 offset:40704
    ds_read_b64_tr_b16 v[176:177], v164 offset:43008
    ds_read_b64_tr_b16 v[178:179], v164 offset:43776
    ds_read_b64_tr_b16 v[180:181], v164 offset:46080
    ds_read_b64_tr_b16 v[182:183], v164 offset:46848
    s_waitcnt lgkmcnt(0)
    s_setprio 1
    v_mfma_f32_16x16x32_bf16 v[200:203], v[208:211], v[168:171], v[200:203]
    v_mfma_f32_16x16x32_bf16 v[200:203], v[208:211], v[172:175], v[200:203]
    v_mfma_f32_16x16x32_bf16 v[200:203], v[208:211], v[176:179], v[200:203]
    v_mfma_f32_16x16x32_bf16 v[200:203], v[208:211], v[180:183], v[200:203]
    s_setprio 0
    s_load_dword s100, s[32:33], 0
    s_add_u32 m0, s56, 16384
    s_add_u32 s62, s61, s59
    s_lshl_b32 s62, s62, 7
    s_add_u32 s63, s62, 12288
    buffer_load_dwordx4 v152, s[8:11], s62 offen offset:0 lds
    buffer_load_dwordx4 v153, s[8:11], s62 offen offset:1024 lds
    buffer_load_dwordx4 v152, s[8:11], s63 offen offset:2048 lds
    buffer_load_dwordx4 v153, s[8:11], s63 offen offset:3072 lds
    s_add_u32 m0, s57, 12288
    s_mul_i32 s62, s59, 172032
    buffer_load_dwordx4 v156, s[12:15], s62 offen offset:0 lds
    buffer_load_dwordx4 v157, s[12:15], s62 offen offset:1024 lds
    buffer_load_dwordx4 v158, s[12:15], s62 offen offset:2048 lds
    s_add_u32 s59, s59, 1
    s_cmp_eq_u32 s59, 7
    s_cselect_b32 s59, 0, s59
    s_waitcnt vmcnt(7)
    s_barrier
    s_mov_b32 s60, 0
    s_waitcnt lgkmcnt(0)
    s_cmp_lg_u32 s100, 0
    s_cbranch_scc1 L_nok_2
L_non_1:
    buffer_load_dword v228, off, s[32:35], 0 sc1
    s_waitcnt vmcnt(0)
    v_readfirstlane_b32 s100, v228
    s_add_u32 s60, s60, 1
    s_cmp_lg_u32 s100, 0
    s_cbranch_scc1 L_nok_2
    s_sleep 8
    s_cmp_lt_u32 s60, 0x10000
    s_cbranch_scc1 L_non_1
L_nok_2:
    s_mov_b32 s101, s100
    v_mov_b32 v228, 161808
    v_mov_b32 v229, s100
    ds_write_b32 v228, v229
    s_add_u32 m0, s56, 32768
    s_add_u32 s62, s61, s59
    s_lshl_b32 s62, s62, 7
    s_add_u32 s63, s62, 12288
    buffer_load_dwordx4 v152, s[8:11], s62 offen offset:0 lds
    ds_read_b64_tr_b16 v[168:169], v164 offset:0
    ds_read_b64_tr_b16 v[170:171], v164 offset:768
    buffer_load_dwordx4 v153, s[8:11], s62 offen offset:1024 lds
    ds_read_b64_tr_b16 v[172:173], v164 offset:3072
    ds_read_b64_tr_b16 v[174:175], v164 offset:3840
    buffer_load_dwordx4 v152, s[8:11], s63 offen offset:2048 lds
    ds_read_b64_tr_b16 v[176:177], v164 offset:6144
    ds_read_b64_tr_b16 v[178:179], v164 offset:6912
    buffer_load_dwordx4 v153, s[8:11], s63 offen offset:3072 lds
    s_add_u32 m0, s57, 24576
    s_mul_i32 s62, s59, 172032
    buffer_load_dwordx4 v156, s[12:15], s62 offen offset:0 lds
    ds_read_b64_tr_b16 v[180:181], v164 offset:9216
    ds_read_b64_tr_b16 v[182:183], v164 offset:9984
    buffer_load_dwordx4 v157, s[12:15], s62 offen offset:1024 lds
    s_waitcnt lgkmcnt(0)
    s_setprio 1
    v_mfma_f32_16x16x32_bf16 v[200:203], v[208:211], v[168:171], v[200:203]
    v_mfma_f32_16x16x32_bf16 v[200:203], v[208:211], v[172:175], v[200:203]
    v_mfma_f32_16x16x32_bf16 v[200:203], v[208:211], v[176:179], v[200:203]
    v_mfma_f32_16x16x32_bf16 v[200:203], v[208:211], v[180:183], v[200:203]
    s_setprio 0
    buffer_load_dwordx4 v158, s[12:15], s62 offen offset:2048 lds
    s_add_u32 s59, s59, 1
    s_cmp_eq_u32 s59, 7
    s_cselect_b32 s59, 0, s59
    s_waitcnt vmcnt(7)
    s_barrier
    s_add_u32 m0, s55, 114688
    s_mul_i32 s62, s59, 229376
    buffer_load_dwordx4 v160, s[20:23], s62 offen offset:0 lds
    ds_read_b64_tr_b16 v[168:169], v164 offset:12288
    ds_read_b64_tr_b16 v[170:171], v164 offset:13056
    buffer_load_dwordx4 v161, s[20:23], s62 offen offset:1024 lds
    s_add_u32 s59, s59, 1
    s_cmp_eq_u32 s59, 7
    s_cselect_b32 s59, 0, s59
    ds_read_b64_tr_b16 v[172:173], v164 offset:15360
    ds_read_b64_tr_b16 v[174:175], v164 offset:16128
    s_add_u32 m0, s55, 122880
    s_mul_i32 s62, s59, 229376
    buffer_load_dwordx4 v160, s[20:23], s62 offen offset:0 lds
    buffer_load_dwordx4 v161, s[20:23], s62 offen offset:1024 lds
    s_add_u32 s59, s59, 1
    s_cmp_eq_u32 s59, 7
    s_cselect_b32 s59, 0, s59
    ds_read_b64_tr_b16 v[176:177], v164 offset:18432
    ds_read_b64_tr_b16 v[178:179], v164 offset:19200
    s_add_u32 m0, s55, 131072
    s_mul_i32 s62, s59, 229376
    buffer_load_dwordx4 v160, s[20:23], s62 offen offset:0 lds
    ds_read_b64_tr_b16 v[180:181], v164 offset:21504
    ds_read_b64_tr_b16 v[182:183], v164 offset:22272
    buffer_load_dwordx4 v161, s[20:23], s62 offen offset:1024 lds
    s_add_u32 s59, s59, 1
    s_cmp_eq_u32 s59, 7
    s_cselect_b32 s59, 0, s59
    s_add_u32 m0, s55, 139264
    s_mul_i32 s62, s59, 229376
    buffer_load_dwordx4 v160, s[20:23], s62 offen offset:0 lds
    s_waitcnt lgkmcnt(0)
    s_setprio 1
    v_mfma_f32_16x16x32_bf16 v[200:203], v[208:211], v[168:171], v[200:203]
    v_mfma_f32_16x16x32_bf16 v[200:203], v[208:211], v[172:175], v[200:203]
    v_mfma_f32_16x16x32_bf16 v[200:203], v[208:211], v[176:179], v[200:203]
    v_mfma_f32_16x16x32_bf16 v[200:203], v[208:211], v[180:183], v[200:203]
    s_setprio 0
    buffer_load_dwordx4 v161, s[20:23], s62 offen offset:1024 lds
    s_add_u32 s59, s59, 1
    s_cmp_eq_u32 s59, 7
    s_cselect_b32 s59, 0, s59
    s_waitcnt vmcnt(8)
    s_barrier
    ds_read_b64_tr_b16 v[168:169], v164 offset:24576
    ds_read_b64_tr_b16 v[170:171], v164 offset:25344
    ds_read_b64_tr_b16 v[172:173], v164 offset:27648
    ds_read_b64_tr_b16 v[174:175], v164 offset:28416
    ds_read_b64_tr_b16 v[176:177], v164 offset:30720
    ds_read_b64_tr_b16 v[178:179], v164 offset:31488
    ds_read_b64_tr_b16 v[180:181], v164 offset:33792
    ds_read_b64_tr_b16 v[182:183], v164 offset:34560
    s_add_u32 m0, s55, 0
    s_mul_i32 s62, s59, 229376
    buffer_load_dwordx4 v160, s[20:23], s62 offen offset:0 lds
    buffer_load_dwordx4 v161, s[20:23], s62 offen offset:1024 lds
    s_add_u32 s59, s59, 1
    s_cmp_eq_u32 s59, 7
    s_cselect_b32 s59, 0, s59
    s_waitcnt lgkmcnt(0)
    s_setprio 1
    v_mfma_f32_16x16x32_bf16 v[200:203], v[208:211], v[168:171], v[200:203]
    v_mfma_f32_16x16x32_bf16 v[200:203], v[208:211], v[172:175], v[200:203]
    v_mfma_f32_16x16x32_bf16 v[200:203], v[208:211], v[176:179], v[200:203]
    v_mfma_f32_16x16x32_bf16 v[200:203], v[208:211], v[180:183], v[200:203]
    s_setprio 0
    s_setprio 1
    s_nop 5
    v_cndmask_b32 v200, 0, v200, s[78:79]
    v_cvt_pk_bf16_f32 v224, v200, v200
    v_and_b32 v225, 0xffff0000, v224
    v_sub_f32 v225, v200, v225
    v_cvt_pk_bf16_f32 v225, v225, v225
    s_setprio 0
    ds_write_b64 v166, v[224:225] offset:0
    s_add_u32 m0, s55, 8192
    s_mul_i32 s62, s59, 229376
    buffer_load_dwordx4 v160, s[20:23], s62 offen offset:0 lds
    buffer_load_dwordx4 v161, s[20:23], s62 offen offset:1024 lds
    s_add_u32 s59, s59, 1
    s_cmp_eq_u32 s59, 7
    s_cselect_b32 s59, 0, s59
    s_add_u32 m0, s55, 16384
    s_mul_i32 s62, s59, 229376
    buffer_load_dwordx4 v160, s[20:23], s62 offen offset:0 lds
    buffer_load_dwordx4 v161, s[20:23], s62 offen offset:1024 lds
    s_add_u32 s59, s59, 1
    s_cmp_eq_u32 s59, 7
    s_cselect_b32 s59, 0, s59
    s_add_u32 m0, s55, 57344
    s_mul_i32 s62, s59, 229376
    s_add_u32 s62, s62, 128
    buffer_load_dwordx4 v160, s[20:23], s62 offen offset:0 lds
    buffer_load_dwordx4 v161, s[20:23], s62 offen offset:1024 lds
    s_add_u32 s59, s59, 1
    s_cmp_eq_u32 s59, 7
    s_cselect_b32 s59, 0, s59
    s_add_u32 m0, s55, 65536
    s_mul_i32 s62, s59, 229376
    s_add_u32 s62, s62, 128
    buffer_load_dwordx4 v160, s[20:23], s62 offen offset:0 lds
    buffer_load_dwordx4 v161, s[20:23], s62 offen offset:1024 lds
    s_add_u32 s59, s59, 1
    s_cmp_eq_u32 s59, 7
    s_cselect_b32 s59, 0, s59
    s_add_u32 m0, s55, 73728
    s_mul_i32 s62, s59, 229376
    s_add_u32 s62, s62, 128
    buffer_load_dwordx4 v160, s[20:23], s62 offen offset:0 lds
    buffer_load_dwordx4 v161, s[20:23], s62 offen offset:1024 lds
    s_add_u32 s59, s59, 1
    s_cmp_eq_u32 s59, 7
    s_cselect_b32 s59, 0, s59
    s_add_u32 m0, s55, 81920
    s_mul_i32 s62, s59, 229376
    s_add_u32 s62, s62, 128
    buffer_load_dwordx4 v160, s[20:23], s62 offen offset:0 lds
    buffer_load_dwordx4 v161, s[20:23], s62 offen offset:1024 lds
    s_add_u32 s59, s59, 1
    s_cmp_eq_u32 s59, 7
    s_cselect_b32 s59, 0, s59
    s_waitcnt vmcnt(14)
    s_waitcnt lgkmcnt(0)
    s_barrier
    s_add_u32 m0, s55, 90112
    s_mul_i32 s62, s59, 229376
    s_add_u32 s62, s62, 128
    buffer_load_dwordx4 v160, s[20:23], s62 offen offset:0 lds
    ds_read_b64_tr_b16 v[168:169], v162 offset:49152
    ds_read_b64_tr_b16 v[170:171], v162 offset:49664
    ds_read_b64_tr_b16 v[172:173], v162 offset:51200
    ds_read_b64_tr_b16 v[174:175], v162 offset:51712
    buffer_load_dwordx4 v161, s[20:23], s62 offen offset:1024 lds
    s_add_u32 s59, s59, 1
    s_cmp_eq_u32 s59, 7
    s_cselect_b32 s59, 0, s59
    ds_read_b64_tr_b16 v[176:177], v162 offset:57344
    ds_read_b64_tr_b16 v[178:179], v162 offset:57856
    s_add_u32 m0, s55, 98304
    s_mul_i32 s62, s59, 229376
    s_add_u32 s62, s62, 128
    buffer_load_dwordx4 v160, s[20:23], s62 offen offset:0 lds
    ds_read_b64_tr_b16 v[180:181], v162 offset:59392
    ds_read_b64_tr_b16 v[182:183], v162 offset:59904
    buffer_load_dwordx4 v161, s[20:23], s62 offen offset:1024 lds
    s_add_u32 s59, s59, 1
    s_cmp_eq_u32 s59, 7
    s_cselect_b32 s59, 0, s59
    ds_read_b64_tr_b16 v[136:137], v163 offset:0
    ds_read_b64_tr_b16 v[138:139], v163 offset:512
    ds_read_b64_tr_b16 v[140:141], v163 offset:2048
    ds_read_b64_tr_b16 v[142:143], v163 offset:2560
    s_add_u32 m0, s55, 106496
    s_mul_i32 s62, s59, 229376
    s_add_u32 s62, s62, 128
    buffer_load_dwordx4 v160, s[20:23], s62 offen offset:0 lds
    ds_read_b64_tr_b16 v[144:145], v163 offset:8192
    ds_read_b64_tr_b16 v[146:147], v163 offset:8704
    buffer_load_dwordx4 v161, s[20:23], s62 offen offset:1024 lds
    s_add_u32 s59, s59, 1
    s_cmp_eq_u32 s59, 7
    s_cselect_b32 s59, 0, s59
    ds_read_b64_tr_b16 v[148:149], v163 offset:10240
    ds_read_b64_tr_b16 v[150:151], v163 offset:10752
    s_add_u32 m0, s89, 24576
    s_mul_i32 s62, s94, 114688
    s_add_u32 s62, s62, s87
    buffer_load_dwordx4 v2, s[24:27], s62 offen offset:0 lds
    buffer_load_dwordx4 v3, s[24:27], s62 offen offset:1024 lds
    s_add_u32 s94, s94, 1
    s_cmp_eq_u32 s94, 14
    s_cselect_b32 s94, 0, s94
    s_add_u32 m0, s89, 26624
    s_mul_i32 s62, s94, 114688
    s_add_u32 s62, s62, s87
    buffer_load_dwordx4 v2, s[24:27], s62 offen offset:0 lds
    buffer_load_dwordx4 v3, s[24:27], s62 offen offset:1024 lds
    s_add_u32 s94, s94, 1
    s_cmp_eq_u32 s94, 14
    s_cselect_b32 s94, 0, s94
    s_add_u32 m0, s89, 28672
    s_mul_i32 s62, s94, 114688
    s_add_u32 s62, s62, s87
    buffer_load_dwordx4 v2, s[24:27], s62 offen offset:0 lds
    buffer_load_dwordx4 v3, s[24:27], s62 offen offset:1024 lds
    s_add_u32 s94, s94, 1
    s_cmp_eq_u32 s94, 14
    s_cselect_b32 s94, 0, s94
    s_waitcnt lgkmcnt(0)
    s_setprio 1
    v_mfma_f32_16x16x32_bf16 v[200:203], v[208:211], v[168:171], 0
    v_mfma_f32_16x16x32_bf16 v[200:203], v[208:211], v[172:175], v[200:203]
    v_mfma_f32_16x16x32_bf16 v[200:203], v[208:211], v[176:179], v[200:203]
    v_mfma_f32_16x16x32_bf16 v[200:203], v[208:211], v[180:183], v[200:203]
    v_mfma_f32_16x16x32_bf16 v[200:203], v[208:211], v[136:139], v[200:203]
    v_mfma_f32_16x16x32_bf16 v[200:203], v[208:211], v[140:143], v[200:203]
    v_mfma_f32_16x16x32_bf16 v[200:203], v[208:211], v[144:147], v[200:203]
    v_mfma_f32_16x16x32_bf16 v[200:203], v[208:211], v[148:151], v[200:203]
    s_setprio 0
    s_waitcnt vmcnt(20)
    s_barrier
    s_add_u32 m0, s55, 114688
    s_mul_i32 s62, s94, 114688
    s_add_u32 s62, s62, s87
    buffer_load_dwordx4 v2, s[24:27], s62 offen offset:0 lds
    ds_read_b64_tr_b16 v[168:169], v165 offset:0
    ds_read_b64_tr_b16 v[170:171], v165 offset:512
    ds_read_b64_tr_b16 v[172:173], v165 offset:2048
    ds_read_b64_tr_b16 v[174:175], v165 offset:2560
    buffer_load_dwordx4 v3, s[24:27], s62 offen offset:1024 lds
    s_add_u32 s94, s94, 1
    s_cmp_eq_u32 s94, 14
    s_cselect_b32 s94, 0, s94
    ds_read_b64_tr_b16 v[176:177], v165 offset:8192
    ds_read_b64_tr_b16 v[178:179], v165 offset:8704
    ds_read_b64_tr_b16 v[180:181], v165 offset:10240
    ds_read_b64_tr_b16 v[182:183], v165 offset:10752
    s_add_u32 m0, s55, 122880
    s_mul_i32 s62, s94, 114688
    s_add_u32 s62, s62, s87
    buffer_load_dwordx4 v2, s[24:27], s62 offen offset:0 lds
    ds_read_b64_tr_b16 v[136:137], v165 offset:16384
    ds_read_b64_tr_b16 v[138:139], v165 offset:16896
    ds_read_b64_tr_b16 v[140:141], v165 offset:18432
    ds_read_b64_tr_b16 v[142:143], v165 offset:18944
    buffer_load_dwordx4 v3, s[24:27], s62 offen offset:1024 lds
    s_add_u32 s94, s94, 1
    s_cmp_eq_u32 s94, 14
    s_cselect_b32 s94, 0, s94
    s_waitcnt lgkmcnt(0)
    s_setprio 1
    v_mfma_f32_16x16x32_bf16 v[200:203], v[208:211], v[168:171], v[200:203]
    v_mfma_f32_16x16x32_bf16 v[200:203], v[208:211], v[172:175], v[200:203]
    v_mfma_f32_16x16x32_bf16 v[200:203], v[208:211], v[176:179], v[200:203]
    v_mfma_f32_16x16x32_bf16 v[200:203], v[208:211], v[180:183], v[200:203]
    v_mfma_f32_16x16x32_bf16 v[200:203], v[208:211], v[136:139], v[200:203]
    v_mfma_f32_16x16x32_bf16 v[200:203], v[208:211], v[140:143], v[200:203]
    s_setprio 0
    s_setprio 1
    s_nop 5
    v_cndmask_b32 v200, 0, v200, s[78:79]
    v_cvt_pk_bf16_f32 v224, v200, v200
    v_and_b32 v225, 0xffff0000, v224
    v_sub_f32 v225, v200, v225
    v_cvt_pk_bf16_f32 v225, v225, v225
    s_setprio 0
    ds_write_b64 v167, v[224:225] offset:0
    s_add_u32 m0, s55, 131072
    s_mul_i32 s62, s94, 114688
    s_add_u32 s62, s62, s87
    buffer_load_dwordx4 v2, s[24:27], s62 offen offset:0 lds
    buffer_load_dwordx4 v3, s[24:27], s62 offen offset:1024 lds
    s_add_u32 s94, s94, 1
    s_cmp_eq_u32 s94, 14
    s_cselect_b32 s94, 0, s94
    s_add_u32 m0, s55, 139264
    s_mul_i32 s62, s94, 114688
    s_add_u32 s62, s62, s87
    buffer_load_dwordx4 v2, s[24:27], s62 offen offset:0 lds
    buffer_load_dwordx4 v3, s[24:27], s62 offen offset:1024 lds
    s_add_u32 s94, s94, 1
    s_cmp_eq_u32 s94, 14
    s_cselect_b32 s94, 0, s94
    s_add_u32 m0, s55, 147456
    s_mul_i32 s62, s94, 114688
    s_add_u32 s62, s62, s87
    buffer_load_dwordx4 v2, s[24:27], s62 offen offset:0 lds
    buffer_load_dwordx4 v3, s[24:27], s62 offen offset:1024 lds
    s_add_u32 s94, s94, 1
    s_cmp_eq_u32 s94, 14
    s_cselect_b32 s94, 0, s94
    s_waitcnt vmcnt(16)
    s_waitcnt lgkmcnt(0)
    s_barrier
    s_lshl2_add_u32 s54, s41, 161824
    v_mov_b32 v1, s54
    s_mov_b32 s57, s95
    s_mov_b32 s63, s87
    s_mov_b32 s61, s94
    s_mul_i32 s58, s46, 7
    s_add_u32 s58, s58, s47
    s_mul_i32 s58, s58, 4352
    s_add_u32 s58, s58, 17956864
    s_mul_i32 s56, s46, 229376
    s_lshl_b32 s54, s41, 10
    s_add_u32 s56, s56, s54
    s_add_u32 s56, s56, 6291456
    s_waitcnt vmcnt(10)
    ds_read_b64_tr_b16 v[8:9], v246 offset:24576
    ds_read_b64_tr_b16 v[10:11], v246 offset:25088
    ds_read_b64_tr_b16 v[12:13], v247 offset:24576
    ds_read_b64_tr_b16 v[14:15], v247 offset:25088
    ds_read_b64_tr_b16 v[16:17], v246 offset:26624
    ds_read_b64_tr_b16 v[18:19], v246 offset:27136
    ds_read_b64_tr_b16 v[20:21], v247 offset:26624
    ds_read_b64_tr_b16 v[22:23], v247 offset:27136
    ds_read_b64_tr_b16 v[24:25], v246 offset:28672
    ds_read_b64_tr_b16 v[26:27], v246 offset:29184
    ds_read_b64_tr_b16 v[28:29], v247 offset:28672
    ds_read_b64_tr_b16 v[30:31], v247 offset:29184
    ds_read_b64_tr_b16 v[168:169], v165 offset:57344
    ds_read_b64_tr_b16 v[170:171], v165 offset:57856
    ds_read_b64_tr_b16 v[172:173], v165 offset:59392
    ds_read_b64_tr_b16 v[174:175], v165 offset:59904
    ds_read_b64_tr_b16 v[176:177], v162 offset:0
    ds_read_b64_tr_b16 v[178:179], v162 offset:512
    ds_read_b64_tr_b16 v[180:181], v162 offset:2048
    ds_read_b64_tr_b16 v[182:183], v162 offset:2560
    ds_read_b64_tr_b16 v[136:137], v162 offset:8192
    ds_read_b64_tr_b16 v[138:139], v162 offset:8704
    ds_read_b64_tr_b16 v[140:141], v162 offset:10240
    ds_read_b64_tr_b16 v[142:143], v162 offset:10752
    ds_read_b64_tr_b16 v[144:145], v162 offset:16384
    ds_read_b64_tr_b16 v[146:147], v162 offset:16896
    ds_read_b64_tr_b16 v[148:149], v162 offset:18432
    ds_read_b64_tr_b16 v[150:151], v162 offset:18944
    ds_read_b64_tr_b16 v[228:229], v162 offset:24576
    ds_read_b64_tr_b16 v[230:231], v162 offset:25088
    ds_read_b64_tr_b16 v[232:233], v162 offset:26624
    ds_read_b64_tr_b16 v[234:235], v162 offset:27136
    ds_read_b64_tr_b16 v[236:237], v162 offset:32768
    ds_read_b64_tr_b16 v[238:239], v162 offset:33280
    ds_read_b64_tr_b16 v[216:217], v162 offset:34816
    ds_read_b64_tr_b16 v[218:219], v162 offset:35328
    ds_read_b64_tr_b16 v[220:221], v162 offset:40960
    ds_read_b64_tr_b16 v[222:223], v162 offset:41472
    ds_read_b64_tr_b16 v[240:241], v162 offset:43008
    ds_read_b64_tr_b16 v[242:243], v162 offset:43520
    s_mov_b64 s[4:5], s[78:79]
    s_waitcnt vmcnt(8)
    ds_read_b64_tr_b16 v[32:33], v248 offset:49152
    ds_read_b64_tr_b16 v[34:35], v248 offset:49664
    ds_read_b64_tr_b16 v[36:37], v249 offset:49152
    ds_read_b64_tr_b16 v[38:39], v249 offset:49664
    s_waitcnt lgkmcnt(0)
    s_add_u32 m0, s55, 114688
    s_mul_i32 s62, s61, 114688
    s_add_u32 s62, s62, s63
    buffer_load_dwordx4 v2, s[24:27], s62 offen offset:0 lds
    buffer_load_dwordx4 v3, s[24:27], s62 offen offset:1024 lds
    s_add_u32 s61, s61, 1
    s_cmp_eq_u32 s61, 14
    s_cselect_b32 s61, 0, s61
    s_waitcnt vmcnt(8)
    ds_read_b64_tr_b16 v[40:41], v248 offset:57344
    ds_read_b64_tr_b16 v[42:43], v248 offset:57856
    ds_read_b64_tr_b16 v[44:45], v249 offset:57344
    ds_read_b64_tr_b16 v[46:47], v249 offset:57856
    s_waitcnt lgkmcnt(0)
    s_add_u32 m0, s55, 122880
    s_mul_i32 s62, s61, 114688
    s_add_u32 s62, s62, s63
    buffer_load_dwordx4 v2, s[24:27], s62 offen offset:0 lds
    buffer_load_dwordx4 v3, s[24:27], s62 offen offset:1024 lds
    s_add_u32 s61, s61, 1
    s_cmp_eq_u32 s61, 14
    s_cselect_b32 s61, 0, s61
    s_setprio 1
    v_mfma_f32_16x16x32_bf16 v[200:203], v[208:211], v[168:171], 0
    v_mfma_f32_16x16x32_bf16 v[200:203], v[208:211], v[172:175], v[200:203]
    v_mfma_f32_16x16x32_bf16 v[200:203], v[208:211], v[176:179], v[200:203]
    v_mfma_f32_16x16x32_bf16 v[200:203], v[208:211], v[180:183], v[200:203]
    v_mfma_f32_16x16x32_bf16 v[200:203], v[208:211], v[136:139], v[200:203]
    v_mfma_f32_16x16x32_bf16 v[200:203], v[208:211], v[140:143], v[200:203]
    v_mfma_f32_16x16x32_bf16 v[200:203], v[208:211], v[144:147], v[200:203]
    v_mfma_f32_16x16x32_bf16 v[200:203], v[208:211], v[148:151], v[200:203]
    v_mfma_f32_16x16x32_bf16 v[200:203], v[208:211], v[228:231], v[200:203]
    v_mfma_f32_16x16x32_bf16 v[200:203], v[208:211], v[232:235], v[200:203]
    v_mfma_f32_16x16x32_bf16 v[200:203], v[208:211], v[236:239], v[200:203]
    v_mfma_f32_16x16x32_bf16 v[200:203], v[208:211], v[216:219], v[200:203]
    v_mfma_f32_16x16x32_bf16 v[200:203], v[208:211], v[220:223], v[200:203]
    v_mfma_f32_16x16x32_bf16 v[200:203], v[208:211], v[240:243], v[200:203]
    s_setprio 0
    s_setprio 1
    s_nop 5
    v_cndmask_b32 v200, 0, v200, s[78:79]
    v_cvt_pk_bf16_f32 v224, v200, v200
    v_and_b32 v225, 0xffff0000, v224
    v_sub_f32 v225, v200, v225
    v_cvt_pk_bf16_f32 v225, v225, v225
    s_setprio 0
    ds_write_b64 v167, v[224:225] offset:2048
    s_mov_b64 exec, 1
    ds_add_u32 v212, v213
    s_mov_b64 exec, -1
    s_mov_b64 s[4:5], s[78:79]
    s_waitcnt vmcnt(8)
    ds_read_b64_tr_b16 v[48:49], v250 offset:0
    ds_read_b64_tr_b16 v[50:51], v250 offset:512
    ds_read_b64_tr_b16 v[52:53], v251 offset:0
    ds_read_b64_tr_b16 v[54:55], v251 offset:512
    s_waitcnt lgkmcnt(0)
    s_add_u32 m0, s55, 131072
    s_mul_i32 s62, s61, 114688
    s_add_u32 s62, s62, s63
    buffer_load_dwordx4 v2, s[24:27], s62 offen offset:0 lds
    buffer_load_dwordx4 v3, s[24:27], s62 offen offset:1024 lds
    s_add_u32 s61, s61, 1
    s_cmp_eq_u32 s61, 14
    s_cselect_b32 s61, 0, s61
    s_waitcnt vmcnt(8)
    ds_read_b64_tr_b16 v[56:57], v250 offset:8192
    ds_read_b64_tr_b16 v[58:59], v250 offset:8704
    ds_read_b64_tr_b16 v[60:61], v251 offset:8192
    ds_read_b64_tr_b16 v[62:63], v251 offset:8704
    s_waitcnt lgkmcnt(0)
    s_add_u32 m0, s55, 139264
    s_mul_i32 s62, s61, 114688
    s_add_u32 s62, s62, s63
    buffer_load_dwordx4 v2, s[24:27], s62 offen offset:0 lds
    buffer_load_dwordx4 v3, s[24:27], s62 offen offset:1024 lds
    s_add_u32 s61, s61, 1
    s_cmp_eq_u32 s61, 14
    s_cselect_b32 s61, 0, s61
    s_waitcnt vmcnt(8)
    ds_read_b64_tr_b16 v[64:65], v250 offset:16384
    ds_read_b64_tr_b16 v[66:67], v250 offset:16896
    ds_read_b64_tr_b16 v[68:69], v251 offset:16384
    ds_read_b64_tr_b16 v[70:71], v251 offset:16896
    s_waitcnt lgkmcnt(0)
    s_add_u32 m0, s55, 147456
    s_mul_i32 s62, s61, 114688
    s_add_u32 s62, s62, s63
    buffer_load_dwordx4 v2, s[24:27], s62 offen offset:0 lds
    buffer_load_dwordx4 v3, s[24:27], s62 offen offset:1024 lds
    s_add_u32 s61, s61, 1
    s_cmp_eq_u32 s61, 14
    s_cselect_b32 s61, 0, s61
    s_waitcnt vmcnt(8)
    ds_read_b64_tr_b16 v[72:73], v248 offset:49152
    ds_read_b64_tr_b16 v[74:75], v248 offset:49664
    ds_read_b64_tr_b16 v[76:77], v249 offset:49152
    ds_read_b64_tr_b16 v[78:79], v249 offset:49664
    s_waitcnt lgkmcnt(0)
    s_add_u32 m0, s55, 114688
    s_mul_i32 s62, s61, 114688
    s_add_u32 s62, s62, s63
    buffer_load_dwordx4 v2, s[24:27], s62 offen offset:0 lds
    buffer_load_dwordx4 v3, s[24:27], s62 offen offset:1024 lds
    s_add_u32 s61, s61, 1
    s_cmp_eq_u32 s61, 14
    s_cselect_b32 s61, 0, s61
    s_add_u32 s63, s63, 57344
    s_waitcnt vmcnt(8)
    ds_read_b64_tr_b16 v[80:81], v248 offset:57344
    ds_read_b64_tr_b16 v[82:83], v248 offset:57856
    ds_read_b64_tr_b16 v[84:85], v249 offset:57344
    ds_read_b64_tr_b16 v[86:87], v249 offset:57856
    s_waitcnt lgkmcnt(0)
    s_add_u32 m0, s55, 122880
    s_mul_i32 s62, s61, 114688
    s_add_u32 s62, s62, s63
    buffer_load_dwordx4 v2, s[24:27], s62 offen offset:0 lds
    buffer_load_dwordx4 v3, s[24:27], s62 offen offset:1024 lds
    s_add_u32 s61, s61, 1
    s_cmp_eq_u32 s61, 14
    s_cselect_b32 s61, 0, s61
    s_load_dwordx16 s[64:79], s[36:37], s92 glc
    s_waitcnt vmcnt(8)
    ds_read_b64_tr_b16 v[88:89], v250 offset:0
    ds_read_b64_tr_b16 v[90:91], v250 offset:512
    ds_read_b64_tr_b16 v[92:93], v251 offset:0
    ds_read_b64_tr_b16 v[94:95], v251 offset:512
    s_waitcnt lgkmcnt(0)
    s_add_u32 m0, s55, 131072
    s_mul_i32 s62, s61, 114688
    s_add_u32 s62, s62, s63
    buffer_load_dwordx4 v2, s[24:27], s62 offen offset:0 lds
    buffer_load_dwordx4 v3, s[24:27], s62 offen offset:1024 lds
    s_add_u32 s61, s61, 1
    s_cmp_eq_u32 s61, 14
    s_cselect_b32 s61, 0, s61
    s_mov_b32 s60, 0
    s_branch L_spchk_5
L_sp_3:
    s_load_dwordx16 s[64:79], s[36:37], s92 glc
L_spchk_5:
    s_waitcnt lgkmcnt(0)
    s_cmp_lt_u32 s49, 2
    s_cselect_b64 s[72:73], s[100:101], s[72:73]
    s_cselect_b64 s[74:75], s[100:101], s[74:75]
    s_cmp_lt_u32 s49, 1
    s_cselect_b64 s[68:69], s[100:101], s[68:69]
    s_cselect_b64 s[70:71], s[100:101], s[70:71]
    s_xor_b64 s[64:65], s[64:65], s[100:101]
    s_xor_b64 s[66:67], s[66:67], s[100:101]
    s_xor_b64 s[68:69], s[68:69], s[100:101]
    s_xor_b64 s[70:71], s[70:71], s[100:101]
    s_xor_b64 s[72:73], s[72:73], s[100:101]
    s_xor_b64 s[74:75], s[74:75], s[100:101]
    s_xor_b64 s[76:77], s[76:77], s[100:101]
    s_or_b64 s[64:65], s[64:65], s[66:67]
    s_or_b64 s[64:65], s[64:65], s[68:69]
    s_or_b64 s[64:65], s[64:65], s[70:71]
    s_or_b64 s[64:65], s[64:65], s[72:73]
    s_or_b64 s[64:65], s[64:65], s[74:75]
    s_or_b64 s[64:65], s[64:65], s[76:77]
    s_cbranch_scc1 L_spno_6
    s_branch L_spok_4
L_spno_6:
    s_add_u32 s60, s60, 1
    s_sleep 2
    s_cmp_lt_u32 s60, 0x10000
    s_cbranch_scc1 L_sp_3
L_spok_4:
    s_add_u32 m0, s88, 49152
    s_nop 0
    buffer_load_dwordx4 v204, s[36:39], s86 offen offset:0 sc1 lds
    buffer_load_dwordx4 v204, s[36:39], s86 offen offset:1024 sc1 lds
    s_add_u32 m0, s89, 0
    s_nop 0
    buffer_load_dwordx4 v204, s[36:39], s80 offen offset:0 sc1 lds
    buffer_load_dwordx4 v204, s[36:39], s80 offen offset:1024 sc1 lds
    s_add_u32 m0, s89, 2048
    s_nop 0
    buffer_load_dwordx4 v204, s[36:39], s82 offen offset:0 sc1 lds
    buffer_load_dwordx4 v204, s[36:39], s82 offen offset:1024 sc1 lds
    s_add_u32 m0, s89, 4096
    s_nop 0
    buffer_load_dwordx4 v204, s[36:39], s84 offen offset:0 sc1 lds
    buffer_load_dwordx4 v204, s[36:39], s84 offen offset:1024 sc1 lds
    s_add_u32 m0, s89, 24576
    s_nop 0
    buffer_load_dwordx4 v204, s[36:39], s81 offen offset:0 sc1 lds
    buffer_load_dwordx4 v204, s[36:39], s81 offen offset:1024 sc1 lds
    s_add_u32 m0, s89, 26624
    s_nop 0
    buffer_load_dwordx4 v204, s[36:39], s83 offen offset:0 sc1 lds
    buffer_load_dwordx4 v204, s[36:39], s83 offen offset:1024 sc1 lds
    s_add_u32 m0, s89, 28672
    s_nop 0
    buffer_load_dwordx4 v204, s[36:39], s85 offen offset:0 sc1 lds
    buffer_load_dwordx4 v204, s[36:39], s85 offen offset:1024 sc1 lds
    s_waitcnt vmcnt(22)
    ds_read_b64_tr_b16 v[96:97], v250 offset:8192
    ds_read_b64_tr_b16 v[98:99], v250 offset:8704
    ds_read_b64_tr_b16 v[100:101], v251 offset:8192
    ds_read_b64_tr_b16 v[102:103], v251 offset:8704
    s_waitcnt lgkmcnt(0)
    s_add_u32 m0, s55, 139264
    s_mul_i32 s62, s61, 114688
    s_add_u32 s62, s62, s63
    buffer_load_dwordx4 v2, s[24:27], s62 offen offset:0 lds
    buffer_load_dwordx4 v3, s[24:27], s62 offen offset:1024 lds
    s_add_u32 s61, s61, 1
    s_cmp_eq_u32 s61, 14
    s_cselect_b32 s61, 0, s61
    s_waitcnt vmcnt(22)
    ds_read_b64_tr_b16 v[104:105], v250 offset:16384
    ds_read_b64_tr_b16 v[106:107], v250 offset:16896
    ds_read_b64_tr_b16 v[108:109], v251 offset:16384
    ds_read_b64_tr_b16 v[110:111], v251 offset:16896
    s_waitcnt lgkmcnt(0)
    s_add_u32 m0, s55, 147456
    s_mul_i32 s62, s61, 114688
    s_add_u32 s62, s62, s63
    buffer_load_dwordx4 v2, s[24:27], s62 offen offset:0 lds
    buffer_load_dwordx4 v3, s[24:27], s62 offen offset:1024 lds
    s_add_u32 s61, s61, 1
    s_cmp_eq_u32 s61, 14
    s_cselect_b32 s61, 0, s61
    s_mul_i32 s4, s41, 100352
    s_lshl_b32 s5, s47, 7
    s_add_u32 s4, s4, s5
    s_mul_i32 s5, s41, 14336
L_w1free_7:
    ds_read_b32 v214, v212
    s_waitcnt lgkmcnt(0)
    v_readfirstlane_b32 s60, v214
    s_nop 0
    s_cmp_ge_u32 s60, 8
    s_cbranch_scc1 L_w1free_7ok
    s_sleep 1
    s_branch L_w1free_7
L_w1free_7ok:
    s_add_u32 m0, s5, 57344
    s_nop 0
    buffer_load_dwordx4 v2, s[16:19], s4 offen offset:0 lds
    buffer_load_dwordx4 v3, s[16:19], s4 offen offset:1024 lds
    s_add_u32 s4, s4, 14336
    s_waitcnt vmcnt(6)
    ds_write_b64 v184, v[190:191]
    ds_write_b64 v185, v[192:193]
    ds_write_b64 v184, v[188:189] offset:24576
    ds_write_b64 v187, v[188:189] offset:24576
    s_mov_b64 exec, 1
    ds_add_u32 v212, v213 offset:4
    s_mov_b64 exec, -1
    s_waitcnt lgkmcnt(0)
    s_load_dwordx16 s[64:79], s[36:37], s58 glc
    s_add_u32 m0, s5, 59392
    s_nop 0
    buffer_load_dwordx4 v2, s[16:19], s4 offen offset:0 lds
    buffer_load_dwordx4 v3, s[16:19], s4 offen offset:1024 lds
    s_add_u32 s4, s4, 14336
    s_add_u32 m0, s5, 61440
    s_nop 0
    buffer_load_dwordx4 v2, s[16:19], s4 offen offset:0 lds
    buffer_load_dwordx4 v3, s[16:19], s4 offen offset:1024 lds
    s_add_u32 s4, s4, 14336
    s_add_u32 m0, s5, 63488
    s_nop 0
    buffer_load_dwordx4 v2, s[16:19], s4 offen offset:0 lds
    buffer_load_dwordx4 v3, s[16:19], s4 offen offset:1024 lds
    s_add_u32 s4, s4, 14336
    s_add_u32 m0, s5, 65536
    s_nop 0
    buffer_load_dwordx4 v2, s[16:19], s4 offen offset:0 lds
    buffer_load_dwordx4 v3, s[16:19], s4 offen offset:1024 lds
    s_add_u32 s4, s4, 14336
    s_add_u32 m0, s5, 67584
    s_nop 0
    buffer_load_dwordx4 v2, s[16:19], s4 offen offset:0 lds
    buffer_load_dwordx4 v3, s[16:19], s4 offen offset:1024 lds
    s_add_u32 s4, s4, 14336
    s_add_u32 m0, s5, 69632
    s_nop 0
    buffer_load_dwordx4 v2, s[16:19], s4 offen offset:0 lds
    buffer_load_dwordx4 v3, s[16:19], s4 offen offset:1024 lds
    s_add_u32 s4, s4, 14336
    s_mov_b32 s60, 0
    s_branch L_spchk_10
L_sp_8:
    s_load_dwordx16 s[64:79], s[36:37], s58 glc
L_spchk_10:
    s_waitcnt lgkmcnt(0)
    s_xor_b64 s[64:65], s[64:65], s[100:101]
    s_xor_b64 s[66:67], s[66:67], s[100:101]
    s_xor_b64 s[68:69], s[68:69], s[100:101]
    s_xor_b64 s[70:71], s[70:71], s[100:101]
    s_xor_b64 s[72:73], s[72:73], s[100:101]
    s_xor_b64 s[74:75], s[74:75], s[100:101]
    s_xor_b64 s[76:77], s[76:77], s[100:101]
    s_or_b64 s[64:65], s[64:65], s[66:67]
    s_or_b64 s[64:65], s[64:65], s[68:69]
    s_or_b64 s[64:65], s[64:65], s[70:71]
    s_or_b64 s[64:65], s[64:65], s[72:73]
    s_or_b64 s[64:65], s[64:65], s[74:75]
    s_or_b64 s[64:65], s[64:65], s[76:77]
    s_cbranch_scc1 L_spno_11
    s_branch L_spok_9
L_spno_11:
    s_add_u32 s60, s60, 1
    s_sleep 2
    s_cmp_lt_u32 s60, 0x10000
    s_cbranch_scc1 L_sp_8
L_spok_9:
    s_lshl_b32 s54, s57, 13
    s_add_u32 s54, s54, s56
    buffer_load_dwordx4 v[216:219], v252, s[36:39], s54 offen sc1
    buffer_load_dwordx4 v[220:223], v253, s[36:39], s54 offen sc1
    s_add_u32 s57, s57, 1
    s_cmp_eq_u32 s57, 14
    s_cselect_b32 s57, 0, s57
    s_lshl_b32 s54, s57, 13
    s_add_u32 s54, s54, s56
    buffer_load_dwordx4 v[224:227], v252, s[36:39], s54 offen sc1
    buffer_load_dwordx4 v[228:231], v253, s[36:39], s54 offen sc1
    s_add_u32 s57, s57, 1
    s_cmp_eq_u32 s57, 14
    s_cselect_b32 s57, 0, s57
    s_lshl_b32 s54, s57, 13
    s_add_u32 s54, s54, s56
    buffer_load_dwordx4 v[232:235], v252, s[36:39], s54 offen sc1
    buffer_load_dwordx4 v[236:239], v253, s[36:39], s54 offen sc1
    s_add_u32 s57, s57, 1
    s_cmp_eq_u32 s57, 14
    s_cselect_b32 s57, 0, s57
    s_lshl_b32 s54, s57, 13
    s_add_u32 s54, s54, s56
    buffer_load_dwordx4 v[136:139], v252, s[36:39], s54 offen sc1
    buffer_load_dwordx4 v[140:143], v253, s[36:39], s54 offen sc1
    s_add_u32 s57, s57, 1
    s_cmp_eq_u32 s57, 14
    s_cselect_b32 s57, 0, s57
    s_lshl_b32 s54, s57, 13
    s_add_u32 s54, s54, s56
    buffer_load_dwordx4 v[144:147], v252, s[36:39], s54 offen sc1
    buffer_load_dwordx4 v[148:151], v253, s[36:39], s54 offen sc1
    s_add_u32 s57, s57, 1
    s_cmp_eq_u32 s57, 14
    s_cselect_b32 s57, 0, s57
    ds_read_b64_tr_b16 v[112:113], v248 offset:49152
    ds_read_b64_tr_b16 v[114:115], v248 offset:49664
    ds_read_b64_tr_b16 v[116:117], v249 offset:49152
    ds_read_b64_tr_b16 v[118:119], v249 offset:49664
    s_waitcnt lgkmcnt(0)
    s_add_u32 m0, s55, 114688
    s_mul_i32 s62, s61, 114688
    s_add_u32 s62, s62, s63
    buffer_load_dwordx4 v2, s[24:27], s62 offen offset:0 lds
    buffer_load_dwordx4 v3, s[24:27], s62 offen offset:1024 lds
    s_add_u32 s61, s61, 1
    s_cmp_eq_u32 s61, 14
    s_cselect_b32 s61, 0, s61
    ds_read_b64_tr_b16 v[120:121], v248 offset:57344
    ds_read_b64_tr_b16 v[122:123], v248 offset:57856
    ds_read_b64_tr_b16 v[124:125], v249 offset:57344
    ds_read_b64_tr_b16 v[126:127], v249 offset:57856
    s_waitcnt lgkmcnt(0)
    s_add_u32 m0, s55, 122880
    s_mul_i32 s62, s61, 114688
    s_add_u32 s62, s62, s63
    buffer_load_dwordx4 v2, s[24:27], s62 offen offset:0 lds
    buffer_load_dwordx4 v3, s[24:27], s62 offen offset:1024 lds
    s_add_u32 s61, s61, 1
    s_cmp_eq_u32 s61, 14
    s_cselect_b32 s61, 0, s61
    ds_read_b64_tr_b16 v[128:129], v250 offset:0
    ds_read_b64_tr_b16 v[130:131], v250 offset:512
    ds_read_b64_tr_b16 v[132:133], v251 offset:0
    ds_read_b64_tr_b16 v[134:135], v251 offset:512
    s_waitcnt lgkmcnt(0)
    s_add_u32 m0, s55, 131072
    s_mul_i32 s62, s61, 114688
    s_add_u32 s62, s62, s63
    buffer_load_dwordx4 v2, s[24:27], s62 offen offset:0 lds
    buffer_load_dwordx4 v3, s[24:27], s62 offen offset:1024 lds
    s_add_u32 s61, s61, 1
    s_cmp_eq_u32 s61, 14
    s_cselect_b32 s61, 0, s61
    s_add_u32 s58, s58, 1114240
    s_setprio 0
    s_waitcnt vmcnt(14)
    ds_write_b32 v1, v245
    v_mfma_f32_32x32x16_bf16 v[152:167], v[8:11], v[216:219], 0
    v_mfma_f32_32x32x16_bf16 v[168:183], v[12:15], v[216:219], 0
    v_mfma_f32_32x32x16_bf16 v[184:199], v[8:11], v[220:223], 0
    v_mfma_f32_32x32x16_bf16 v[200:215], v[12:15], v[220:223], 0
    s_waitcnt vmcnt(12)
    v_mfma_f32_32x32x16_bf16 v[152:167], v[16:19], v[224:227], v[152:167]
    s_lshl_b32 s54, s57, 13
    s_add_u32 s54, s54, s56
    buffer_load_dwordx4 v[216:219], v252, s[36:39], s54 offen sc1
    v_mfma_f32_32x32x16_bf16 v[168:183], v[20:23], v[224:227], v[168:183]
    buffer_load_dwordx4 v[220:223], v253, s[36:39], s54 offen sc1
    s_add_u32 s57, s57, 1
    s_cmp_eq_u32 s57, 14
    s_cselect_b32 s57, 0, s57
    v_mfma_f32_32x32x16_bf16 v[184:199], v[16:19], v[228:231], v[184:199]
    s_lshl_b32 s54, s57, 13
    s_add_u32 s54, s54, s56
    buffer_load_dwordx4 v[8:11], v252, s[36:39], s54 offen sc1
    v_mfma_f32_32x32x16_bf16 v[200:215], v[20:23], v[228:231], v[200:215]
    buffer_load_dwordx4 v[12:15], v253, s[36:39], s54 offen sc1
    s_add_u32 s57, s57, 1
    s_cmp_eq_u32 s57, 14
    s_cselect_b32 s57, 0, s57
    s_waitcnt vmcnt(14)
    v_mfma_f32_32x32x16_bf16 v[152:167], v[24:27], v[232:235], v[152:167]
    s_lshl_b32 s54, s57, 13
    s_add_u32 s54, s54, s56
    buffer_load_dwordx4 v[224:227], v252, s[36:39], s54 offen sc1
    v_mfma_f32_32x32x16_bf16 v[168:183], v[28:31], v[232:235], v[168:183]
    buffer_load_dwordx4 v[228:231], v253, s[36:39], s54 offen sc1
    s_add_u32 s57, s57, 1
    s_cmp_eq_u32 s57, 14
    s_cselect_b32 s57, 0, s57
    v_mfma_f32_32x32x16_bf16 v[184:199], v[24:27], v[236:239], v[184:199]
    ds_read_b64_tr_b16 v[16:17], v250 offset:8192
    ds_read_b64_tr_b16 v[18:19], v250 offset:8704
    ds_read_b64_tr_b16 v[20:21], v251 offset:8192
    ds_read_b64_tr_b16 v[22:23], v251 offset:8704
    v_mfma_f32_32x32x16_bf16 v[200:215], v[28:31], v[236:239], v[200:215]
    s_waitcnt vmcnt(14)
    v_mfma_f32_32x32x16_bf16 v[152:167], v[32:35], v[136:139], v[152:167]
    s_waitcnt lgkmcnt(0)
    s_add_u32 m0, s55, 139264
    s_mul_i32 s62, s61, 114688
    s_add_u32 s62, s62, s63
    buffer_load_dwordx4 v2, s[24:27], s62 offen offset:0 lds
    buffer_load_dwordx4 v3, s[24:27], s62 offen offset:1024 lds
    s_add_u32 s61, s61, 1
    s_cmp_eq_u32 s61, 14
    s_cselect_b32 s61, 0, s61
    v_mfma_f32_32x32x16_bf16 v[168:183], v[36:39], v[136:139], v[168:183]
    s_lshl_b32 s54, s57, 13
    s_add_u32 s54, s54, s56
    buffer_load_dwordx4 v[232:235], v252, s[36:39], s54 offen sc1
    buffer_load_dwordx4 v[236:239], v253, s[36:39], s54 offen sc1
    s_add_u32 s57, s57, 1
    s_cmp_eq_u32 s57, 14
    s_cselect_b32 s57, 0, s57
    v_mfma_f32_32x32x16_bf16 v[184:199], v[32:35], v[140:143], v[184:199]
    ds_read_b64_tr_b16 v[24:25], v250 offset:16384
    ds_read_b64_tr_b16 v[26:27], v250 offset:16896
    ds_read_b64_tr_b16 v[28:29], v251 offset:16384
    ds_read_b64_tr_b16 v[30:31], v251 offset:16896
    v_mfma_f32_32x32x16_bf16 v[200:215], v[36:39], v[140:143], v[200:215]
    s_waitcnt vmcnt(16)
    v_mfma_f32_32x32x16_bf16 v[152:167], v[40:43], v[144:147], v[152:167]
    s_waitcnt lgkmcnt(0)
    s_add_u32 m0, s55, 147456
    s_mul_i32 s62, s61, 114688
    s_add_u32 s62, s62, s63
    buffer_load_dwordx4 v2, s[24:27], s62 offen offset:0 lds
    buffer_load_dwordx4 v3, s[24:27], s62 offen offset:1024 lds
    s_add_u32 s61, s61, 1
    s_cmp_eq_u32 s61, 14
    s_cselect_b32 s61, 0, s61
    v_mfma_f32_32x32x16_bf16 v[168:183], v[44:47], v[144:147], v[168:183]
    s_lshl_b32 s54, s57, 13
    s_add_u32 s54, s54, s56
    buffer_load_dwordx4 v[136:139], v252, s[36:39], s54 offen sc1
    buffer_load_dwordx4 v[140:143], v253, s[36:39], s54 offen sc1
    s_add_u32 s57, s57, 1
    s_cmp_eq_u32 s57, 14
    s_cselect_b32 s57, 0, s57
    v_mfma_f32_32x32x16_bf16 v[184:199], v[40:43], v[148:151], v[184:199]
    s_waitcnt vmcnt(18)
    ds_read_b64_tr_b16 v[32:33], v248 offset:49152
    ds_read_b64_tr_b16 v[34:35], v248 offset:49664
    ds_read_b64_tr_b16 v[36:37], v249 offset:49152
    ds_read_b64_tr_b16 v[38:39], v249 offset:49664
    v_mfma_f32_32x32x16_bf16 v[200:215], v[44:47], v[148:151], v[200:215]
    s_waitcnt vmcnt(12)
    v_mfma_f32_32x32x16_bf16 v[152:167], v[48:51], v[216:219], v[152:167]
    s_waitcnt lgkmcnt(0)
    s_add_u32 m0, s55, 114688
    s_mul_i32 s62, s61, 114688
    s_add_u32 s62, s62, s63
    buffer_load_dwordx4 v2, s[24:27], s62 offen offset:0 lds
    buffer_load_dwordx4 v3, s[24:27], s62 offen offset:1024 lds
    s_add_u32 s61, s61, 1
    s_cmp_eq_u32 s61, 14
    s_cselect_b32 s61, 0, s61
    v_mfma_f32_32x32x16_bf16 v[168:183], v[52:55], v[216:219], v[168:183]
    s_lshl_b32 s54, s57, 13
    s_add_u32 s54, s54, s56
    buffer_load_dwordx4 v[144:147], v252, s[36:39], s54 offen sc1
    buffer_load_dwordx4 v[148:151], v253, s[36:39], s54 offen sc1
    s_add_u32 s57, s57, 1
    s_cmp_eq_u32 s57, 14
    s_cselect_b32 s57, 0, s57
    v_mfma_f32_32x32x16_bf16 v[184:199], v[48:51], v[220:223], v[184:199]
    ds_read_b64_tr_b16 v[40:41], v248 offset:57344
    ds_read_b64_tr_b16 v[42:43], v248 offset:57856
    ds_read_b64_tr_b16 v[44:45], v249 offset:57344
    ds_read_b64_tr_b16 v[46:47], v249 offset:57856
    v_mfma_f32_32x32x16_bf16 v[200:215], v[52:55], v[220:223], v[200:215]
    s_waitcnt vmcnt(14)
    v_mfma_f32_32x32x16_bf16 v[152:167], v[56:59], v[8:11], v[152:167]
    s_waitcnt lgkmcnt(0)
    s_add_u32 m0, s55, 122880
    s_mul_i32 s62, s61, 114688
    s_add_u32 s62, s62, s63
    buffer_load_dwordx4 v2, s[24:27], s62 offen offset:0 lds
    buffer_load_dwordx4 v3, s[24:27], s62 offen offset:1024 lds
    s_add_u32 s61, s61, 1
    s_cmp_eq_u32 s61, 14
    s_cselect_b32 s61, 0, s61
    v_mfma_f32_32x32x16_bf16 v[168:183], v[60:63], v[8:11], v[168:183]
    s_lshl_b32 s54, s57, 13
    s_add_u32 s54, s54, s56
    buffer_load_dwordx4 v[216:219], v252, s[36:39], s54 offen sc1
    buffer_load_dwordx4 v[220:223], v253, s[36:39], s54 offen sc1
    s_add_u32 s57, s57, 1
    s_cmp_eq_u32 s57, 14
    s_cselect_b32 s57, 0, s57
    v_mfma_f32_32x32x16_bf16 v[184:199], v[56:59], v[12:15], v[184:199]
    ds_read_b64_tr_b16 v[48:49], v250 offset:0
    ds_read_b64_tr_b16 v[50:51], v250 offset:512
    ds_read_b64_tr_b16 v[52:53], v251 offset:0
    ds_read_b64_tr_b16 v[54:55], v251 offset:512
    v_mfma_f32_32x32x16_bf16 v[200:215], v[60:63], v[12:15], v[200:215]
    s_waitcnt vmcnt(16)
    v_mfma_f32_32x32x16_bf16 v[152:167], v[64:67], v[224:227], v[152:167]
    s_waitcnt lgkmcnt(0)
    s_add_u32 m0, s55, 131072
    s_mul_i32 s62, s61, 114688
    s_add_u32 s62, s62, s63
    buffer_load_dwordx4 v2, s[24:27], s62 offen offset:0 lds
    buffer_load_dwordx4 v3, s[24:27], s62 offen offset:1024 lds
    s_add_u32 s61, s61, 1
    s_cmp_eq_u32 s61, 14
    s_cselect_b32 s61, 0, s61
    v_mfma_f32_32x32x16_bf16 v[168:183], v[68:71], v[224:227], v[168:183]
    s_lshl_b32 s54, s57, 13
    s_add_u32 s54, s54, s56
    buffer_load_dwordx4 v[8:11], v252, s[36:39], s54 offen sc1
    buffer_load_dwordx4 v[12:15], v253, s[36:39], s54 offen sc1
    s_add_u32 s57, s57, 1
    s_cmp_eq_u32 s57, 14
    s_cselect_b32 s57, 0, s57
    s_load_dwordx16 s[64:79], s[36:37], s58 glc
    v_mfma_f32_32x32x16_bf16 v[184:199], v[64:67], v[228:231], v[184:199]
    s_waitcnt vmcnt(18)
    ds_read_b64_tr_b16 v[56:57], v250 offset:8192
    ds_read_b64_tr_b16 v[58:59], v250 offset:8704
    ds_read_b64_tr_b16 v[60:61], v251 offset:8192
    ds_read_b64_tr_b16 v[62:63], v251 offset:8704
    v_mfma_f32_32x32x16_bf16 v[200:215], v[68:71], v[228:231], v[200:215]
    s_waitcnt vmcnt(16)
    v_mfma_f32_32x32x16_bf16 v[152:167], v[72:75], v[232:235], v[152:167]
    s_waitcnt lgkmcnt(0)
    s_add_u32 m0, s55, 139264
    s_mul_i32 s62, s61, 114688
    s_add_u32 s62, s62, s63
    buffer_load_dwordx4 v2, s[24:27], s62 offen offset:0 lds
    buffer_load_dwordx4 v3, s[24:27], s62 offen offset:1024 lds
    s_add_u32 s61, s61, 1
    s_cmp_eq_u32 s61, 14
    s_cselect_b32 s61, 0, s61
    v_mfma_f32_32x32x16_bf16 v[168:183], v[76:79], v[232:235], v[168:183]
    s_lshl_b32 s54, s57, 13
    s_add_u32 s54, s54, s56
    buffer_load_dwordx4 v[224:227], v252, s[36:39], s54 offen sc1
    buffer_load_dwordx4 v[228:231], v253, s[36:39], s54 offen sc1
    s_add_u32 s57, s57, 1
    s_cmp_eq_u32 s57, 14
    s_cselect_b32 s57, 0, s57
    s_add_u32 s56, s56, 4096
    v_mfma_f32_32x32x16_bf16 v[184:199], v[72:75], v[236:239], v[184:199]
    s_waitcnt vmcnt(18)
    ds_read_b64_tr_b16 v[64:65], v250 offset:16384
    ds_read_b64_tr_b16 v[66:67], v250 offset:16896
    ds_read_b64_tr_b16 v[68:69], v251 offset:16384
    ds_read_b64_tr_b16 v[70:71], v251 offset:16896
    v_mfma_f32_32x32x16_bf16 v[200:215], v[76:79], v[236:239], v[200:215]
    s_waitcnt vmcnt(16)
    v_mfma_f32_32x32x16_bf16 v[152:167], v[80:83], v[136:139], v[152:167]
    s_waitcnt lgkmcnt(0)
    s_add_u32 m0, s55, 147456
    s_mul_i32 s62, s61, 114688
    s_add_u32 s62, s62, s63
    buffer_load_dwordx4 v2, s[24:27], s62 offen offset:0 lds
    buffer_load_dwordx4 v3, s[24:27], s62 offen offset:1024 lds
    s_add_u32 s61, s61, 1
    s_cmp_eq_u32 s61, 14
    s_cselect_b32 s61, 0, s61
    v_mfma_f32_32x32x16_bf16 v[168:183], v[84:87], v[136:139], v[168:183]
    s_mov_b32 s60, 0
    s_branch L_spchk_14
L_sp_12:
    s_load_dwordx16 s[64:79], s[36:37], s58 glc
L_spchk_14:
    s_waitcnt lgkmcnt(0)
    s_xor_b64 s[64:65], s[64:65], s[100:101]
    s_xor_b64 s[66:67], s[66:67], s[100:101]
    s_xor_b64 s[68:69], s[68:69], s[100:101]
    s_xor_b64 s[70:71], s[70:71], s[100:101]
    s_xor_b64 s[72:73], s[72:73], s[100:101]
    s_xor_b64 s[74:75], s[74:75], s[100:101]
    s_xor_b64 s[76:77], s[76:77], s[100:101]
    s_or_b64 s[64:65], s[64:65], s[66:67]
    s_or_b64 s[64:65], s[64:65], s[68:69]
    s_or_b64 s[64:65], s[64:65], s[70:71]
    s_or_b64 s[64:65], s[64:65], s[72:73]
    s_or_b64 s[64:65], s[64:65], s[74:75]
    s_or_b64 s[64:65], s[64:65], s[76:77]
    s_cbranch_scc1 L_spno_15
    s_branch L_spok_13
L_spno_15:
    s_add_u32 s60, s60, 1
    s_sleep 2
    s_cmp_lt_u32 s60, 0x10000
    s_cbranch_scc1 L_sp_12
L_spok_13:
    s_lshl_b32 s54, s57, 13
    s_add_u32 s54, s54, s56
    buffer_load_dwordx4 v[232:235], v252, s[36:39], s54 offen sc1
    buffer_load_dwordx4 v[236:239], v253, s[36:39], s54 offen sc1
    s_add_u32 s57, s57, 1
    s_cmp_eq_u32 s57, 14
    s_cselect_b32 s57, 0, s57
    v_mfma_f32_32x32x16_bf16 v[184:199], v[80:83], v[140:143], v[184:199]
    s_waitcnt vmcnt(18)
    ds_read_b64_tr_b16 v[72:73], v248 offset:49152
    ds_read_b64_tr_b16 v[74:75], v248 offset:49664
    ds_read_b64_tr_b16 v[76:77], v249 offset:49152
    ds_read_b64_tr_b16 v[78:79], v249 offset:49664
    v_mfma_f32_32x32x16_bf16 v[200:215], v[84:87], v[140:143], v[200:215]
    s_waitcnt vmcnt(16)
    v_mfma_f32_32x32x16_bf16 v[152:167], v[88:91], v[144:147], v[152:167]
    s_lshl_b32 s54, s57, 13
    s_add_u32 s54, s54, s56
    buffer_load_dwordx4 v[136:139], v252, s[36:39], s54 offen sc1
    v_mfma_f32_32x32x16_bf16 v[168:183], v[92:95], v[144:147], v[168:183]
    buffer_load_dwordx4 v[140:143], v253, s[36:39], s54 offen sc1
    s_add_u32 s57, s57, 1
    s_cmp_eq_u32 s57, 14
    s_cselect_b32 s57, 0, s57
    v_mfma_f32_32x32x16_bf16 v[184:199], v[88:91], v[148:151], v[184:199]
    s_waitcnt vmcnt(16)
    ds_read_b64_tr_b16 v[80:81], v248 offset:57344
    ds_read_b64_tr_b16 v[82:83], v248 offset:57856
    ds_read_b64_tr_b16 v[84:85], v249 offset:57344
    ds_read_b64_tr_b16 v[86:87], v249 offset:57856
    v_mfma_f32_32x32x16_bf16 v[200:215], v[92:95], v[148:151], v[200:215]
    s_waitcnt vmcnt(14)
    v_mfma_f32_32x32x16_bf16 v[152:167], v[96:99], v[216:219], v[152:167]
    s_lshl_b32 s54, s57, 13
    s_add_u32 s54, s54, s56
    buffer_load_dwordx4 v[144:147], v252, s[36:39], s54 offen sc1
    v_mfma_f32_32x32x16_bf16 v[168:183], v[100:103], v[216:219], v[168:183]
    buffer_load_dwordx4 v[148:151], v253, s[36:39], s54 offen sc1
    s_add_u32 s57, s57, 1
    s_cmp_eq_u32 s57, 14
    s_cselect_b32 s57, 0, s57
    v_mfma_f32_32x32x16_bf16 v[184:199], v[96:99], v[220:223], v[184:199]
    s_waitcnt vmcnt(14)
    ds_read_b64_tr_b16 v[88:89], v250 offset:0
    ds_read_b64_tr_b16 v[90:91], v250 offset:512
    ds_read_b64_tr_b16 v[92:93], v251 offset:0
    ds_read_b64_tr_b16 v[94:95], v251 offset:512
    v_mfma_f32_32x32x16_bf16 v[200:215], v[100:103], v[220:223], v[200:215]
    s_setprio 1
    s_waitcnt vmcnt(12)
    v_mfma_f32_32x32x16_bf16 v[152:167], v[104:107], v[8:11], v[152:167]
    s_lshl_b32 s54, s57, 13
    s_add_u32 s54, s54, s56
    buffer_load_dwordx4 v[216:219], v252, s[36:39], s54 offen sc1
    v_mfma_f32_32x32x16_bf16 v[168:183], v[108:111], v[8:11], v[168:183]
    buffer_load_dwordx4 v[220:223], v253, s[36:39], s54 offen sc1
    s_add_u32 s57, s57, 1
    s_cmp_eq_u32 s57, 14
    s_cselect_b32 s57, 0, s57
    v_mfma_f32_32x32x16_bf16 v[184:199], v[104:107], v[12:15], v[184:199]
    s_waitcnt vmcnt(12)
    ds_read_b64_tr_b16 v[96:97], v250 offset:8192
    ds_read_b64_tr_b16 v[98:99], v250 offset:8704
    ds_read_b64_tr_b16 v[100:101], v251 offset:8192
    ds_read_b64_tr_b16 v[102:103], v251 offset:8704
    v_mfma_f32_32x32x16_bf16 v[200:215], v[108:111], v[12:15], v[200:215]
    s_waitcnt vmcnt(10)
    v_mfma_f32_32x32x16_bf16 v[152:167], v[112:115], v[224:227], v[152:167]
    s_lshl_b32 s54, s57, 13
    s_add_u32 s54, s54, s56
    buffer_load_dwordx4 v[8:11], v252, s[36:39], s54 offen sc1
    v_mfma_f32_32x32x16_bf16 v[168:183], v[116:119], v[224:227], v[168:183]
    buffer_load_dwordx4 v[12:15], v253, s[36:39], s54 offen sc1
    s_add_u32 s57, s57, 1
    s_cmp_eq_u32 s57, 14
    s_cselect_b32 s57, 0, s57
    v_mfma_f32_32x32x16_bf16 v[184:199], v[112:115], v[228:231], v[184:199]
    s_waitcnt vmcnt(10)
    ds_read_b64_tr_b16 v[104:105], v250 offset:16384
    ds_read_b64_tr_b16 v[106:107], v250 offset:16896
    ds_read_b64_tr_b16 v[108:109], v251 offset:16384
    ds_read_b64_tr_b16 v[110:111], v251 offset:16896
    v_mfma_f32_32x32x16_bf16 v[200:215], v[116:119], v[228:231], v[200:215]
    s_waitcnt vmcnt(8)
    v_mfma_f32_32x32x16_bf16 v[152:167], v[120:123], v[232:235], v[152:167]
    s_lshl_b32 s54, s57, 13
    s_add_u32 s54, s54, s56
    buffer_load_dwordx4 v[224:227], v252, s[36:39], s54 offen sc1
    v_mfma_f32_32x32x16_bf16 v[168:183], v[124:127], v[232:235], v[168:183]
    buffer_load_dwordx4 v[228:231], v253, s[36:39], s54 offen sc1
    s_add_u32 s57, s57, 1
    s_cmp_eq_u32 s57, 14
    s_cselect_b32 s57, 0, s57
    v_mfma_f32_32x32x16_bf16 v[184:199], v[120:123], v[236:239], v[184:199]
    v_mfma_f32_32x32x16_bf16 v[200:215], v[124:127], v[236:239], v[200:215]
    s_waitcnt vmcnt(8)
    v_mfma_f32_32x32x16_bf16 v[152:167], v[128:131], v[136:139], v[152:167]
    s_lshl_b32 s54, s57, 13
    s_add_u32 s54, s54, s56
    buffer_load_dwordx4 v[112:115], v252, s[36:39], s54 offen sc1
    v_mfma_f32_32x32x16_bf16 v[168:183], v[132:135], v[136:139], v[168:183]
    buffer_load_dwordx4 v[116:119], v253, s[36:39], s54 offen sc1
    s_add_u32 s57, s57, 1
    s_cmp_eq_u32 s57, 14
    s_cselect_b32 s57, 0, s57
    v_mfma_f32_32x32x16_bf16 v[184:199], v[128:131], v[140:143], v[184:199]
    v_mfma_f32_32x32x16_bf16 v[200:215], v[132:135], v[140:143], v[200:215]
    s_waitcnt vmcnt(8)
    v_mfma_f32_32x32x16_bf16 v[152:167], v[16:19], v[144:147], v[152:167]
    s_lshl_b32 s54, s57, 13
    s_add_u32 s54, s54, s56
    buffer_load_dwordx4 v[232:235], v252, s[36:39], s54 offen sc1
    v_mfma_f32_32x32x16_bf16 v[168:183], v[20:23], v[144:147], v[168:183]
    buffer_load_dwordx4 v[236:239], v253, s[36:39], s54 offen sc1
    s_add_u32 s57, s57, 1
    s_cmp_eq_u32 s57, 14
    s_cselect_b32 s57, 0, s57
    v_mfma_f32_32x32x16_bf16 v[184:199], v[16:19], v[148:151], v[184:199]
    v_mfma_f32_32x32x16_bf16 v[200:215], v[20:23], v[148:151], v[200:215]
    s_waitcnt vmcnt(8)
    v_mfma_f32_32x32x16_bf16 v[152:167], v[24:27], v[216:219], v[152:167]
    s_lshl_b32 s54, s57, 13
    s_add_u32 s54, s54, s56
    buffer_load_dwordx4 v[120:123], v252, s[36:39], s54 offen sc1
    v_mfma_f32_32x32x16_bf16 v[168:183], v[28:31], v[216:219], v[168:183]
    buffer_load_dwordx4 v[124:127], v253, s[36:39], s54 offen sc1
    s_add_u32 s57, s57, 1
    s_cmp_eq_u32 s57, 14
    s_cselect_b32 s57, 0, s57
    v_mfma_f32_32x32x16_bf16 v[184:199], v[24:27], v[220:223], v[184:199]
    v_mfma_f32_32x32x16_bf16 v[200:215], v[28:31], v[220:223], v[200:215]
    s_waitcnt vmcnt(8)
    v_mfma_f32_32x32x16_bf16 v[152:167], v[32:35], v[8:11], v[152:167]
    s_lshl_b32 s54, s57, 13
    s_add_u32 s54, s54, s56
    buffer_load_dwordx4 v[136:139], v252, s[36:39], s54 offen sc1
    v_mfma_f32_32x32x16_bf16 v[168:183], v[36:39], v[8:11], v[168:183]
    buffer_load_dwordx4 v[140:143], v253, s[36:39], s54 offen sc1
    s_add_u32 s57, s57, 1
    s_cmp_eq_u32 s57, 14
    s_cselect_b32 s57, 0, s57
    v_mfma_f32_32x32x16_bf16 v[184:199], v[32:35], v[12:15], v[184:199]
    v_mfma_f32_32x32x16_bf16 v[200:215], v[36:39], v[12:15], v[200:215]
    s_waitcnt vmcnt(8)
    v_mfma_f32_32x32x16_bf16 v[152:167], v[40:43], v[224:227], v[152:167]
    s_lshl_b32 s54, s57, 13
    s_add_u32 s54, s54, s56
    buffer_load_dwordx4 v[128:131], v252, s[36:39], s54 offen sc1
    v_mfma_f32_32x32x16_bf16 v[168:183], v[44:47], v[224:227], v[168:183]
    buffer_load_dwordx4 v[132:135], v253, s[36:39], s54 offen sc1
    s_add_u32 s57, s57, 1
    s_cmp_eq_u32 s57, 14
    s_cselect_b32 s57, 0, s57
    v_mfma_f32_32x32x16_bf16 v[184:199], v[40:43], v[228:231], v[184:199]
    v_mfma_f32_32x32x16_bf16 v[200:215], v[44:47], v[228:231], v[200:215]
    s_waitcnt vmcnt(8)
    v_mfma_f32_32x32x16_bf16 v[152:167], v[48:51], v[112:115], v[152:167]
    s_lshl_b32 s54, s57, 13
    s_add_u32 s54, s54, s56
    buffer_load_dwordx4 v[144:147], v252, s[36:39], s54 offen sc1
    v_mfma_f32_32x32x16_bf16 v[168:183], v[52:55], v[112:115], v[168:183]
    buffer_load_dwordx4 v[148:151], v253, s[36:39], s54 offen sc1
    s_add_u32 s57, s57, 1
    s_cmp_eq_u32 s57, 14
    s_cselect_b32 s57, 0, s57
    v_mfma_f32_32x32x16_bf16 v[184:199], v[48:51], v[116:119], v[184:199]
    buffer_load_dwordx4 v[240:243], v244, s[8:11], 0 offen
    v_mfma_f32_32x32x16_bf16 v[200:215], v[52:55], v[116:119], v[200:215]
    s_waitcnt vmcnt(9)
    v_mfma_f32_32x32x16_bf16 v[152:167], v[56:59], v[232:235], v[152:167]
    s_lshl_b32 s54, s57, 13
    s_add_u32 s54, s54, s56
    buffer_load_dwordx4 v[16:19], v252, s[36:39], s54 offen sc1
    v_mfma_f32_32x32x16_bf16 v[168:183], v[60:63], v[232:235], v[168:183]
    buffer_load_dwordx4 v[20:23], v253, s[36:39], s54 offen sc1
    s_add_u32 s57, s57, 1
    s_cmp_eq_u32 s57, 14
    s_cselect_b32 s57, 0, s57
    v_mfma_f32_32x32x16_bf16 v[184:199], v[56:59], v[236:239], v[184:199]
    v_mfma_f32_32x32x16_bf16 v[200:215], v[60:63], v[236:239], v[200:215]
    s_waitcnt vmcnt(9)
    v_mfma_f32_32x32x16_bf16 v[152:167], v[64:67], v[120:123], v[152:167]
    s_lshl_b32 s54, s57, 13
    s_add_u32 s54, s54, s56
    buffer_load_dwordx4 v[216:219], v252, s[36:39], s54 offen sc1
    v_mfma_f32_32x32x16_bf16 v[168:183], v[68:71], v[120:123], v[168:183]
    buffer_load_dwordx4 v[220:223], v253, s[36:39], s54 offen sc1
    s_add_u32 s57, s57, 1
    s_cmp_eq_u32 s57, 14
    s_cselect_b32 s57, 0, s57
    v_mfma_f32_32x32x16_bf16 v[184:199], v[64:67], v[124:127], v[184:199]
    v_mfma_f32_32x32x16_bf16 v[200:215], v[68:71], v[124:127], v[200:215]
    s_waitcnt vmcnt(9) lgkmcnt(15)
    v_mfma_f32_32x32x16_bf16 v[152:167], v[72:75], v[136:139], v[152:167]
    v_mfma_f32_32x32x16_bf16 v[168:183], v[76:79], v[136:139], v[168:183]
    v_mfma_f32_32x32x16_bf16 v[184:199], v[72:75], v[140:143], v[184:199]
    v_mfma_f32_32x32x16_bf16 v[200:215], v[76:79], v[140:143], v[200:215]
    ds_read_b32 v245, v254
    s_waitcnt vmcnt(7) lgkmcnt(13)
    v_mfma_f32_32x32x16_bf16 v[152:167], v[80:83], v[128:131], v[152:167]
    v_mfma_f32_32x32x16_bf16 v[168:183], v[84:87], v[128:131], v[168:183]
    v_mfma_f32_32x32x16_bf16 v[184:199], v[80:83], v[132:135], v[184:199]
    v_mfma_f32_32x32x16_bf16 v[200:215], v[84:87], v[132:135], v[200:215]
L_wofree_16:
    s_waitcnt lgkmcnt(0)
    v_readfirstlane_b32 s60, v245
    s_nop 0
    s_cmp_ge_u32 s60, 4
    s_cbranch_scc1 L_wofree_16ok
    ds_read_b32 v245, v254
    s_branch L_wofree_16
L_wofree_16ok:
    s_waitcnt vmcnt(5)
    v_mfma_f32_32x32x16_bf16 v[152:167], v[88:91], v[144:147], v[152:167]
    s_waitcnt vmcnt(2)
    v_mfma_f32_32x32x16_bf16 v[152:167], v[96:99], v[16:19], v[152:167]
    s_waitcnt vmcnt(0)
    v_mfma_f32_32x32x16_bf16 v[152:167], v[104:107], v[216:219], v[152:167]
    v_mfma_f32_32x32x16_bf16 v[168:183], v[92:95], v[144:147], v[168:183]
    v_mfma_f32_32x32x16_bf16 v[168:183], v[100:103], v[16:19], v[168:183]
    s_nop 9
    ds_write_b128 v4, v[152:155] offset:0
    ds_write_b128 v4, v[156:159] offset:32768
    v_mfma_f32_32x32x16_bf16 v[168:183], v[108:111], v[216:219], v[168:183]
    ds_write_b128 v5, v[160:163] offset:8192
    ds_write_b128 v5, v[164:167] offset:40960
    v_mfma_f32_32x32x16_bf16 v[184:199], v[88:91], v[148:151], v[184:199]
    v_mfma_f32_32x32x16_bf16 v[184:199], v[96:99], v[20:23], v[184:199]
    s_nop 7
    ds_write_b128 v6, v[168:171] offset:16384
    ds_write_b128 v6, v[172:175] offset:49152
    v_mfma_f32_32x32x16_bf16 v[184:199], v[104:107], v[220:223], v[184:199]
    ds_write_b128 v7, v[176:179] offset:24576
    ds_write_b128 v7, v[180:183] offset:57344
    v_mfma_f32_32x32x16_bf16 v[200:215], v[92:95], v[148:151], v[200:215]
    v_mfma_f32_32x32x16_bf16 v[200:215], v[100:103], v[20:23], v[200:215]
    s_nop 7
    ds_write_b128 v4, v[184:187] offset:512
    ds_write_b128 v4, v[188:191] offset:33280
    v_mfma_f32_32x32x16_bf16 v[200:215], v[108:111], v[220:223], v[200:215]
    ds_write_b128 v5, v[192:195] offset:8704
    ds_write_b128 v5, v[196:199] offset:41472
    s_nop 9
    ds_write_b128 v6, v[200:203] offset:16896
    ds_write_b128 v6, v[204:207] offset:49664
    ds_write_b128 v7, v[208:211] offset:25088
    ds_write_b128 v7, v[212:215] offset:57856
    s_branch L_final
L_other:
    v_and_b32 v0, 63, v0
    s_and_b32 s41, s40, 3
    s_mov_b32 s51, 1
    s_mov_b32 s14, 1204224
    s_mov_b32 s15, s11
    s_and_b32 s53, s43, 1
    s_lshl1_add_u32 s48, s42, s53
    s_lshr_b32 s49, s43, 1
    s_mul_i32 s52, s48, 7
    s_lshr_b32 s52, s52, 1
    s_mov_b32 s18, 401408
    s_mov_b32 s19, s11
    s_mov_b32 s22, 1605632
    s_mov_b32 s23, s11
    s_mov_b32 s26, 1605632
    s_mov_b32 s27, s11
    s_mov_b32 s30, 1835008
    s_mov_b32 s31, s11
    s_mov_b32 s34, 256
    s_mov_b32 s35, s11
    s_mov_b32 s38, 26214400
    s_mov_b32 s39, s11
    s_cmp_ge_u32 s40, 4
    s_cbranch_scc1 L_B_help
    s_memrealtime s[60:61]
    s_or_b32 s54, s43, s40
    s_cmp_lg_u32 s54, 0
    s_cbranch_scc1 L_A_common
    v_mov_b32 v9, 0
    s_waitcnt lgkmcnt(0)
    s_or_b32 s60, s60, 1
    v_mov_b32 v8, s60
    s_mov_b64 exec, 1
    buffer_atomic_cmpswap v[8:9], off, s[32:35], 0 sc1
    s_mov_b64 exec, -1
    s_branch L_A_common
L_B_help:
    v_mov_b32 v216, 161792
    v_mov_b32 v217, 0
    ds_write_b32 v216, v217
    ds_write_b32 v216, v217 offset:8
    ds_write_b32 v216, v217 offset:28
    s_lshl_b32 s54, s49, 2
    s_mul_i32 s90, s41, 3
    s_add_u32 s90, s90, s54
    s_add_u32 s91, s54, s41
    v_lshlrev_b32 v204, 4, v0
    s_lshl_b32 s54, s52, 9
    s_mul_i32 s89, s41, 6144
    s_lshl_b32 s88, s41, 11
    s_add_u32 s60, s90, 0
    s_max_u32 s60, s60, 8
    s_sub_u32 s60, s60, 8
    s_mul_i32 s60, s60, 86016
    s_add_u32 s60, s60, s54
    s_add_u32 s80, s60, 28672
    s_add_u32 s81, s60, 57344
    s_add_u32 s60, s90, 1
    s_max_u32 s60, s60, 8
    s_sub_u32 s60, s60, 8
    s_mul_i32 s60, s60, 86016
    s_add_u32 s60, s60, s54
    s_add_u32 s82, s60, 28672
    s_add_u32 s83, s60, 57344
    s_add_u32 s60, s90, 2
    s_max_u32 s60, s60, 8
    s_sub_u32 s60, s60, 8
    s_mul_i32 s60, s60, 86016
    s_add_u32 s60, s60, s54
    s_add_u32 s84, s60, 28672
    s_add_u32 s85, s60, 57344
    s_mul_i32 s86, s91, 86016
    s_add_u32 s86, s86, s54
    s_lshl_b32 s92, s49, 4
    s_add_u32 s92, s92, s48
    s_mul_i32 s92, s92, 4352
    s_add_u32 s92, s92, 16777216
    s_waitcnt lgkmcnt(0)
    v_lshlrev_b32 v200, 7, v0
    s_lshl2_add_u32 s59, s43, s41
    s_and_b32 s55, s59, 7
    s_mul_i32 s55, s55, 7168
    s_lshr_b32 s56, s59, 3
    s_mul_i32 s56, s56, 114688
    s_add_u32 s55, s55, s56
    s_min_u32 s58, s42, 6
    s_mov_b32 s57, 0
    s_mul_i32 s59, s59, 6272
    s_lshl2_add_u32 s54, s2, s41
    s_mul_i32 s56, s54, 12544
    s_bfm_b64 exec, 49, 0
    buffer_load_dword v201, v200, s[24:27], s56 offen
    s_add_u32 s56, s56, 6272
    buffer_load_dword v201, v200, s[24:27], s56 offen
    s_add_u32 s56, s56, 6272
    s_mul_i32 s56, s54, 3136
    s_and_b32 s56, s56, 0xffffff80
    s_bfm_b64 exec, 25, 0
    buffer_load_dword v201, v200, s[16:19], s56 offen
    s_mov_b64 exec, -1
    s_mov_b32 s57, 7
    s_add_u32 s55, s55, 57344
    s_barrier
    s_cmp_eq_u32 s53, 1
    s_cselect_b32 s60, 0, 3
    s_cselect_b32 s62, 0, 1544
    s_add_u32 s60, s60, s52
    s_and_b32 s60, s60, 3
    s_lshl_b32 s60, s60, 6
    v_and_b32 v184, 31, v0
    v_lshlrev_b32 v184, 4, v184
    v_xor_b32 v184, s60, v184
    v_add_u32 v186, s62, v184
    v_cmp_lt_u32 vcc, 31, v0
    s_add_u32 s60, s89, 4096
    s_add_u32 s62, s88, 49152
    v_mov_b32 v184, s60
    v_mov_b32 v185, s62
    v_cndmask_b32 v185, v184, v185, vcc
    v_add_u32 v185, v185, v186
    v_add_u32 v187, v184, v186
    v_lshrrev_b32 v184, 5, v0
    v_lshl_add_u32 v184, v184, 11, v186
    v_add_u32 v184, s89, v184
    v_mov_b32 v188, 0x3f80
    v_mov_b32 v189, 0
    v_mov_b32 v191, 0
    v_mov_b32 v193, 0
    s_cmp_lt_u32 s90, 8
    s_cselect_b32 s60, 0xf14a, 0
    v_mov_b32 v190, s60
    s_cmp_lt_u32 s90, 7
    s_cselect_b32 s60, 0xf14a, 0
    v_mov_b32 v192, s60
    v_cndmask_b32 v190, v190, v192, vcc
    s_cmp_lt_u32 s90, 6
    s_cselect_b32 s60, 0xf14a, 0
    v_mov_b32 v192, s60
    v_cndmask_b32 v192, v192, v188, vcc
    s_mov_b32 s60, 0
L_non_17:
    buffer_load_dword v220, off, s[32:35], 0 sc1
    s_waitcnt vmcnt(0)
    v_readfirstlane_b32 s100, v220
    s_add_u32 s60, s60, 1
    s_cmp_lg_u32 s100, 0
    s_cbranch_scc1 L_nok_18
    s_sleep 8
    s_cmp_lt_u32 s60, 0x10000
    s_cbranch_scc1 L_non_17
L_nok_18:
    s_mov_b32 s101, s100
    s_mov_b32 s60, 0
L_sp_19:
    s_load_dwordx16 s[64:79], s[36:37], s92 glc
L_spchk_21:
    s_waitcnt lgkmcnt(0)
    s_cmp_lt_u32 s49, 2
    s_cselect_b64 s[72:73], s[100:101], s[72:73]
    s_cselect_b64 s[74:75], s[100:101], s[74:75]
    s_cmp_lt_u32 s49, 1
    s_cselect_b64 s[68:69], s[100:101], s[68:69]
    s_cselect_b64 s[70:71], s[100:101], s[70:71]
    s_xor_b64 s[64:65], s[64:65], s[100:101]
    s_xor_b64 s[66:67], s[66:67], s[100:101]
    s_xor_b64 s[68:69], s[68:69], s[100:101]
    s_xor_b64 s[70:71], s[70:71], s[100:101]
    s_xor_b64 s[72:73], s[72:73], s[100:101]
    s_xor_b64 s[74:75], s[74:75], s[100:101]
    s_xor_b64 s[76:77], s[76:77], s[100:101]
    s_or_b64 s[64:65], s[64:65], s[66:67]
    s_or_b64 s[64:65], s[64:65], s[68:69]
    s_or_b64 s[64:65], s[64:65], s[70:71]
    s_or_b64 s[64:65], s[64:65], s[72:73]
    s_or_b64 s[64:65], s[64:65], s[74:75]
    s_or_b64 s[64:65], s[64:65], s[76:77]
    s_cbranch_scc1 L_spno_22
    s_branch L_spok_20
L_spno_22:
    s_add_u32 s60, s60, 1
    s_sleep 8
    s_cmp_lt_u32 s60, 0x10000
    s_cbranch_scc1 L_sp_19
L_spok_20:
    s_add_u32 m0, s88, 49152
    s_nop 0
    buffer_load_dwordx4 v204, s[36:39], s86 offen offset:0 sc1 lds
    buffer_load_dwordx4 v204, s[36:39], s86 offen offset:1024 sc1 lds
    s_add_u32 m0, s89, 0
    s_nop 0
    buffer_load_dwordx4 v204, s[36:39], s80 offen offset:0 sc1 lds
    buffer_load_dwordx4 v204, s[36:39], s80 offen offset:1024 sc1 lds
    s_add_u32 m0, s89, 2048
    s_nop 0
    buffer_load_dwordx4 v204, s[36:39], s82 offen offset:0 sc1 lds
    buffer_load_dwordx4 v204, s[36:39], s82 offen offset:1024 sc1 lds
    s_add_u32 m0, s89, 4096
    s_nop 0
    buffer_load_dwordx4 v204, s[36:39], s84 offen offset:0 sc1 lds
    buffer_load_dwordx4 v204, s[36:39], s84 offen offset:1024 sc1 lds
    s_add_u32 m0, s89, 24576
    s_nop 0
    buffer_load_dwordx4 v204, s[36:39], s81 offen offset:0 sc1 lds
    buffer_load_dwordx4 v204, s[36:39], s81 offen offset:1024 sc1 lds
    s_add_u32 m0, s89, 26624
    s_nop 0
    buffer_load_dwordx4 v204, s[36:39], s83 offen offset:0 sc1 lds
    buffer_load_dwordx4 v204, s[36:39], s83 offen offset:1024 sc1 lds
    s_add_u32 m0, s89, 28672
    s_nop 0
    buffer_load_dwordx4 v204, s[36:39], s85 offen offset:0 sc1 lds
    buffer_load_dwordx4 v204, s[36:39], s85 offen offset:1024 sc1 lds
    s_waitcnt vmcnt(0)
    ds_write_b64 v184, v[190:191]
    ds_write_b64 v185, v[192:193]
    ds_write_b64 v184, v[188:189] offset:24576
    ds_write_b64 v187, v[188:189] offset:24576
    s_mov_b64 exec, 1
    v_mov_b32 v212, 161800
    v_mov_b32 v213, 1
    ds_add_u32 v212, v213
    s_mov_b64 exec, -1
    s_waitcnt lgkmcnt(0)
    s_branch L_fin
L_roleA:
    v_and_b32 v0, 63, v0
    s_and_b32 s41, s40, 3
    s_mov_b32 s51, 0
    s_mov_b32 s14, 1204224
    s_mov_b32 s15, s11
    s_lshl2_add_u32 s46, s42, s50
    s_and_b32 s53, s43, 1
    s_lshl1_add_u32 s48, s42, s53
    s_lshr_b32 s49, s43, 1
    s_mul_i32 s52, s48, 7
    s_lshr_b32 s52, s52, 1
    s_mov_b32 s18, 401408
    s_mov_b32 s19, s11
    s_mov_b32 s22, 1605632
    s_mov_b32 s23, s11
    s_mov_b32 s26, 1605632
    s_mov_b32 s27, s11
    s_mov_b32 s30, 1835008
    s_mov_b32 s31, s11
    s_mov_b32 s34, 256
    s_mov_b32 s35, s11
    s_mov_b32 s38, 26214400
    s_mov_b32 s39, s11
L_A_common:
    v_lshrrev_b32 v8, 5, v0
    v_add_u32 v9, s52, v8
    v_and_b32 v9, 3, v9
    v_lshlrev_b32 v9, 6, v9
    v_and_b32 v10, 31, v0
    v_lshlrev_b32 v11, 4, v10
    v_xor_b32 v9, v9, v11
    v_lshl_or_b32 v250, v8, 9, v9
    s_lshl_b32 s54, s41, 11
    v_add_u32 v250, s54, v250
    v_xor_b32 v251, 0x480, v250
    v_lshlrev_b32 v8, 2, v8
    v_sub_u32 v10, v10, v8
    v_cmp_gt_i32 s[64:65], 0, v10
    v_cmp_gt_i32 s[66:67], 1, v10
    v_cmp_gt_i32 s[68:69], 2, v10
    v_cmp_gt_i32 s[70:71], 3, v10
    v_cmp_gt_i32 s[72:73], 8, v10
    v_cmp_gt_i32 s[74:75], 9, v10
    v_cmp_gt_i32 s[76:77], 10, v10
    v_cmp_gt_i32 s[78:79], 11, v10
    v_cmp_gt_i32 s[80:81], 16, v10
    v_cmp_gt_i32 s[82:83], 17, v10
    v_cmp_gt_i32 s[84:85], 18, v10
    v_cmp_gt_i32 s[86:87], 19, v10
    v_cmp_gt_i32 s[88:89], 24, v10
    v_cmp_gt_i32 s[90:91], 25, v10
    v_cmp_gt_i32 s[92:93], 26, v10
    v_cmp_gt_i32 s[94:95], 27, v10
    v_bfe_u32 v8, v0, 4, 1
    v_and_b32 v9, 1, v0
    v_lshl_or_b32 v8, v8, 1, v9
    v_add_u32 v9, s52, v8
    v_and_b32 v9, 3, v9
    v_lshrrev_b32 v10, 5, v0
    v_xor_b32 v9, v9, v10
    v_lshlrev_b32 v9, 6, v9
    v_lshl_or_b32 v9, v8, 9, v9
    v_bfe_u32 v10, v0, 2, 2
    v_lshl_or_b32 v9, v10, 4, v9
    v_bfe_u32 v10, v0, 1, 1
    v_lshl_or_b32 v9, v10, 3, v9
    v_add_u32 v252, s54, v9
    v_xor_b32 v253, 0x80, v252
    s_cmp_eq_u32 s51, 0
    s_cbranch_scc1 L_A_work
    s_waitcnt lgkmcnt(0)
    s_lshl2_add_u32 s54, s2, s41
    s_mul_i32 s55, s54, 8704
    s_add_u32 s56, s55, 16777216
    s_add_u32 s57, s55, 17956864
    s_add_u32 s58, s55, 19071104
    s_mul_i32 s59, s54, 17408
    s_add_u32 s59, s59, 20250624
    s_load_dword s3, s[36:37], s56 glc
    s_add_u32 s56, s56, 4352
    s_load_dword s3, s[36:37], s56 glc
    s_add_u32 s56, s56, 4352
    s_load_dword s3, s[36:37], s57 glc
    s_add_u32 s57, s57, 4352
    s_load_dword s3, s[36:37], s57 glc
    s_add_u32 s57, s57, 4352
    s_load_dword s3, s[36:37], s58 glc
    s_add_u32 s58, s58, 4352
    s_load_dword s3, s[36:37], s58 glc
    s_add_u32 s58, s58, 4352
    s_load_dword s3, s[36:37], s59 glc
    s_add_u32 s59, s59, 4352
    s_load_dword s3, s[36:37], s59 glc
    s_add_u32 s59, s59, 4352
    s_load_dword s3, s[36:37], s59 glc
    s_add_u32 s59, s59, 4352
    s_load_dword s3, s[36:37], s59 glc
    s_add_u32 s59, s59, 4352
    s_waitcnt lgkmcnt(0)
    s_barrier
    s_mov_b32 s60, 0
L_non_23:
    buffer_load_dword v6, off, s[32:35], 0 sc1
    s_waitcnt vmcnt(0)
    v_readfirstlane_b32 s100, v6
    s_add_u32 s60, s60, 1
    s_cmp_lg_u32 s100, 0
    s_cbranch_scc1 L_nok_24
    s_sleep 8
    s_cmp_lt_u32 s60, 0x10000
    s_cbranch_scc1 L_non_23
L_nok_24:
    s_mov_b32 s101, s100
    s_branch L_A_attn
L_A_work:
    v_and_b32 v228, 31, v0
    v_lshrrev_b32 v229, 5, v0
    v_bfe_u32 v230, v0, 1, 3
    v_xor_b32 v229, v229, v230
    v_lshlrev_b32 v229, 4, v229
    v_lshl_or_b32 v216, v228, 7, v229
    s_lshl_b32 s54, s41, 12
    v_add_u32 v216, s54, v216
    v_xor_b32 v217, 32, v216
    v_xor_b32 v218, 64, v216
    v_xor_b32 v219, 0x60, v216
    v_lshrrev_b32 v228, 5, v0
    v_lshlrev_b32 v228, 3, v228
    v_bfe_u32 v230, v0, 2, 2
    v_add_u32 v228, v228, v230
    v_bfe_u32 v229, v0, 4, 1
    v_lshlrev_b32 v229, 5, v229
    v_and_b32 v231, 1, v0
    v_lshl_or_b32 v229, v231, 4, v229
    v_bfe_u32 v231, v0, 1, 1
    v_lshl_or_b32 v229, v231, 3, v229
    v_mul_u32_u24 v220, 192, v228
    v_add_u32 v220, v220, v229
    v_add_u32 v220, 65536, v220
    v_lshlrev_b32 v221, 7, v228
    v_add_u32 v221, v221, v229
    v_lshrrev_b32 v230, 1, v230
    v_lshl_or_b32 v221, v230, 6, v221
    v_xor_b32 v222, 64, v221
    v_add_u32 v224, 65536, v221
    v_add_u32 v225, 65536, v222
    v_lshlrev_b32 v240, 3, v0
    v_add_u32 v240, 155648, v240
    v_lshlrev_b32 v223, 4, v0
    v_add_u32 v241, 157696, v223
    v_and_b32 v242, 31, v0
    v_lshlrev_b32 v2, 4, v242
    v_lshrrev_b32 v243, 5, v0
    v_mul_u32_u24 v243, 0x240, v243
    v_xor_b32 v242, v2, v243
    v_xor_b32 v243, 0x480, v242
    s_lshl2_add_u32 s54, s44, s41
    s_mul_i32 s55, s54, 86016
    s_mul_i32 s56, s45, 6144
    s_add_u32 s55, s55, s56
    s_add_u32 s56, s55, 4096
    s_mul_i32 s57, s45, 3
    s_mul_i32 s62, s54, 114688
    s_lshl_b32 s63, s45, 13
    s_add_u32 s62, s62, s63
    s_add_u32 s62, s62, 6291456
    s_add_u32 s63, s62, 4096
    s_mul_i32 s7, s44, 60928
    s_lshl2_add_u32 s7, s45, s7
    s_add_u32 s7, s7, 17956864
    v_mul_u32_u24 v7, 4352, v0
    v_mov_b32 v170, 0
    v_mov_b32 v171, 0
    v_mov_b32 v174, 0
    v_mov_b32 v175, 0
    v_mov_b32 v178, 0
    v_mov_b32 v179, 0
    s_mul_i32 s58, s45, 24
    s_mul_i32 s58, s58, 9363
    s_lshr_b32 s58, s58, 16
    s_max_u32 s58, s58, 1
    s_sub_u32 s58, s58, 1
    v_bfe_u32 v8, v0, 1, 3
    v_add_u32 v8, s58, v8
    v_mul_u32_u24 v9, 7, v8
    v_lshrrev_b32 v9, 1, v9
    v_and_b32 v10, 1, v0
    v_mad_u32_u24 v9, v10, 3, v9
    v_mul_u32_u24 v9, 5462, v9
    v_lshrrev_b32 v9, 16, v9
    v_cmp_eq_u32 vcc, s45, v9
    v_cmp_gt_u32 s[60:61], 48, v8
    v_lshrrev_b32 v11, 4, v0
    s_and_b64 vcc, vcc, s[60:61]
    v_cmp_gt_u32 s[60:61], 3, v11
    v_add_u32 v9, s44, v11
    s_and_b64 vcc, vcc, s[60:61]
    v_cmp_gt_u32 s[60:61], 16, v9
    v_lshlrev_b32 v9, 4, v9
    s_and_b64 vcc, vcc, s[60:61]
    v_and_b32 v226, 15, v8
    v_add_u32 v9, v9, v226
    v_mul_u32_u24 v9, 4352, v9
    v_lshl_add_u32 v9, v10, 2, v9
    v_lshrrev_b32 v10, 5, v8
    v_lshlrev_b32 v10, 3, v10
    v_lshl_add_u32 v10, v11, 4, v10
    v_cmp_gt_u32 s[60:61], 16, v8
    v_cmp_lt_u32 s[58:59], 0, v11
    s_nop 0
    v_cndmask_b32 v10, v10, 48, s[60:61]
    s_and_b64 s[58:59], s[58:59], s[60:61]
    s_andn2_b64 vcc, vcc, s[58:59]
    v_add_u32 v9, v9, v10
    v_add_u32 v9, 16777216, v9
    v_mov_b32 v10, 26214400
    v_cndmask_b32 v226, v10, v9, vcc
    v_mov_b32 v227, 161804
    s_mov_b32 s59, 0x3f803f80
    s_add_u32 s58, s57, 0
    s_cmp_lt_u32 s58, 14
    s_cselect_b32 s4, 0x3e8b97f6, 1.0
    s_add_u32 s58, s57, 1
    s_cmp_lt_u32 s58, 14
    s_cselect_b32 s5, 0x3e8b97f6, 1.0
    s_add_u32 s58, s57, 2
    s_cmp_lt_u32 s58, 14
    s_cselect_b32 s6, 0x3e8b97f6, 1.0
    s_waitcnt lgkmcnt(0)
    s_barrier
    ds_read_b128 v[8:11], v216 offset:0
    ds_read_b64_tr_b16 v[184:185], v220 offset:0
    ds_read_b64_tr_b16 v[186:187], v220 offset:768
    ds_read_b64_tr_b16 v[188:189], v220 offset:64
    ds_read_b64_tr_b16 v[190:191], v220 offset:832
    ds_read_b64_tr_b16 v[192:193], v220 offset:128
    ds_read_b64_tr_b16 v[194:195], v220 offset:896
    s_waitcnt lgkmcnt(4)
    v_mfma_f32_32x32x16_bf16 v[120:135], v[184:187], v[8:11], 0
    ds_read_b128 v[12:15], v217 offset:0
    ds_read_b64_tr_b16 v[196:197], v220 offset:3072
    ds_read_b64_tr_b16 v[198:199], v220 offset:3840
    s_waitcnt lgkmcnt(5)
    v_mfma_f32_32x32x16_bf16 v[136:151], v[188:191], v[8:11], 0
    ds_read_b64_tr_b16 v[200:201], v220 offset:3136
    ds_read_b64_tr_b16 v[202:203], v220 offset:3904
    s_waitcnt lgkmcnt(5)
    v_mfma_f32_32x32x16_bf16 v[152:167], v[192:195], v[8:11], 0
    ds_read_b64_tr_b16 v[204:205], v220 offset:3200
    ds_read_b64_tr_b16 v[206:207], v220 offset:3968
    s_waitcnt lgkmcnt(4)
    v_mfma_f32_32x32x16_bf16 v[120:135], v[196:199], v[12:15], v[120:135]
    ds_read_b128 v[16:19], v218 offset:0
    ds_read_b64_tr_b16 v[208:209], v220 offset:6144
    ds_read_b64_tr_b16 v[210:211], v220 offset:6912
    s_waitcnt lgkmcnt(5)
    v_mfma_f32_32x32x16_bf16 v[136:151], v[200:203], v[12:15], v[136:151]
    ds_read_b64_tr_b16 v[212:213], v220 offset:6208
    ds_read_b64_tr_b16 v[214:215], v220 offset:6976
    s_waitcnt lgkmcnt(5)
    v_mfma_f32_32x32x16_bf16 v[152:167], v[204:207], v[12:15], v[152:167]
    ds_read_b64_tr_b16 v[184:185], v220 offset:6272
    ds_read_b64_tr_b16 v[186:187], v220 offset:7040
    s_waitcnt lgkmcnt(4)
    v_mfma_f32_32x32x16_bf16 v[120:135], v[208:211], v[16:19], v[120:135]
    ds_read_b128 v[20:23], v219 offset:0
    ds_read_b64_tr_b16 v[188:189], v220 offset:9216
    ds_read_b64_tr_b16 v[190:191], v220 offset:9984
    s_waitcnt lgkmcnt(5)
    v_mfma_f32_32x32x16_bf16 v[136:151], v[212:215], v[16:19], v[136:151]
    ds_read_b64_tr_b16 v[192:193], v220 offset:9280
    ds_read_b64_tr_b16 v[194:195], v220 offset:10048
    s_waitcnt lgkmcnt(5)
    v_mfma_f32_32x32x16_bf16 v[152:167], v[184:187], v[16:19], v[152:167]
    ds_read_b64_tr_b16 v[196:197], v220 offset:9344
    ds_read_b64_tr_b16 v[198:199], v220 offset:10112
    s_waitcnt lgkmcnt(4)
    v_mfma_f32_32x32x16_bf16 v[120:135], v[188:191], v[20:23], v[120:135]
    v_dot2_f32_bf16 v2, v8, s59, 0
    v_dot2_f32_bf16 v4, v8, v8, 0
    v_dot2_f32_bf16 v3, v9, s59, 0
    v_dot2_f32_bf16 v5, v9, v9, 0
    v_dot2_f32_bf16 v2, v10, s59, v2
    v_dot2_f32_bf16 v4, v10, v10, v4
    v_dot2_f32_bf16 v3, v11, s59, v3
    v_dot2_f32_bf16 v5, v11, v11, v5
    v_dot2_f32_bf16 v2, v12, s59, v2
    v_dot2_f32_bf16 v4, v12, v12, v4
    v_dot2_f32_bf16 v3, v13, s59, v3
    v_dot2_f32_bf16 v5, v13, v13, v5
    v_dot2_f32_bf16 v2, v14, s59, v2
    v_dot2_f32_bf16 v4, v14, v14, v4
    v_dot2_f32_bf16 v3, v15, s59, v3
    v_dot2_f32_bf16 v5, v15, v15, v5
    v_dot2_f32_bf16 v2, v16, s59, v2
    v_dot2_f32_bf16 v4, v16, v16, v4
    v_dot2_f32_bf16 v3, v17, s59, v3
    v_dot2_f32_bf16 v5, v17, v17, v5
    v_dot2_f32_bf16 v2, v18, s59, v2
    v_dot2_f32_bf16 v4, v18, v18, v4
    v_dot2_f32_bf16 v3, v19, s59, v3
    v_dot2_f32_bf16 v5, v19, v19, v5
    v_dot2_f32_bf16 v2, v20, s59, v2
    v_dot2_f32_bf16 v4, v20, v20, v4
    v_dot2_f32_bf16 v3, v21, s59, v3
    v_dot2_f32_bf16 v5, v21, v21, v5
    v_dot2_f32_bf16 v2, v22, s59, v2
    v_dot2_f32_bf16 v4, v22, v22, v4
    v_dot2_f32_bf16 v3, v23, s59, v3
    v_dot2_f32_bf16 v5, v23, v23, v5
    s_waitcnt lgkmcnt(0)
    s_barrier
    ds_read_b128 v[24:27], v216 offset:16384
    ds_read_b64_tr_b16 v[200:201], v220 offset:12288
    ds_read_b64_tr_b16 v[202:203], v220 offset:13056
    v_mfma_f32_32x32x16_bf16 v[136:151], v[192:195], v[20:23], v[136:151]
    ds_read_b64_tr_b16 v[204:205], v220 offset:12352
    ds_read_b64_tr_b16 v[206:207], v220 offset:13120
    v_mfma_f32_32x32x16_bf16 v[152:167], v[196:199], v[20:23], v[152:167]
    ds_read_b64_tr_b16 v[208:209], v220 offset:12416
    ds_read_b64_tr_b16 v[210:211], v220 offset:13184
    s_waitcnt lgkmcnt(4)
    v_mfma_f32_32x32x16_bf16 v[120:135], v[200:203], v[24:27], v[120:135]
    ds_read_b128 v[28:31], v217 offset:16384
    ds_read_b64_tr_b16 v[212:213], v220 offset:15360
    ds_read_b64_tr_b16 v[214:215], v220 offset:16128
    s_waitcnt lgkmcnt(5)
    v_mfma_f32_32x32x16_bf16 v[136:151], v[204:207], v[24:27], v[136:151]
    ds_read_b64_tr_b16 v[184:185], v220 offset:15424
    ds_read_b64_tr_b16 v[186:187], v220 offset:16192
    s_waitcnt lgkmcnt(5)
    v_mfma_f32_32x32x16_bf16 v[152:167], v[208:211], v[24:27], v[152:167]
    ds_read_b64_tr_b16 v[188:189], v220 offset:15488
    ds_read_b64_tr_b16 v[190:191], v220 offset:16256
    s_waitcnt lgkmcnt(4)
    v_mfma_f32_32x32x16_bf16 v[120:135], v[212:215], v[28:31], v[120:135]
    ds_read_b128 v[32:35], v218 offset:16384
    ds_read_b64_tr_b16 v[192:193], v220 offset:18432
    ds_read_b64_tr_b16 v[194:195], v220 offset:19200
    s_waitcnt lgkmcnt(5)
    v_mfma_f32_32x32x16_bf16 v[136:151], v[184:187], v[28:31], v[136:151]
    ds_read_b64_tr_b16 v[196:197], v220 offset:18496
    ds_read_b64_tr_b16 v[198:199], v220 offset:19264
    s_waitcnt lgkmcnt(5)
    v_mfma_f32_32x32x16_bf16 v[152:167], v[188:191], v[28:31], v[152:167]
    ds_read_b64_tr_b16 v[200:201], v220 offset:18560
    ds_read_b64_tr_b16 v[202:203], v220 offset:19328
    s_waitcnt lgkmcnt(4)
    v_mfma_f32_32x32x16_bf16 v[120:135], v[192:195], v[32:35], v[120:135]
    ds_read_b128 v[36:39], v219 offset:16384
    ds_read_b64_tr_b16 v[204:205], v220 offset:21504
    ds_read_b64_tr_b16 v[206:207], v220 offset:22272
    s_waitcnt lgkmcnt(5)
    v_mfma_f32_32x32x16_bf16 v[136:151], v[196:199], v[32:35], v[136:151]
    ds_read_b64_tr_b16 v[208:209], v220 offset:21568
    ds_read_b64_tr_b16 v[210:211], v220 offset:22336
    s_waitcnt lgkmcnt(5)
    v_mfma_f32_32x32x16_bf16 v[152:167], v[200:203], v[32:35], v[152:167]
    ds_read_b64_tr_b16 v[212:213], v220 offset:21632
    ds_read_b64_tr_b16 v[214:215], v220 offset:22400
    s_waitcnt lgkmcnt(4)
    v_mfma_f32_32x32x16_bf16 v[120:135], v[204:207], v[36:39], v[120:135]
    v_dot2_f32_bf16 v2, v24, s59, v2
    v_dot2_f32_bf16 v4, v24, v24, v4
    v_dot2_f32_bf16 v3, v25, s59, v3
    v_dot2_f32_bf16 v5, v25, v25, v5
    v_dot2_f32_bf16 v2, v26, s59, v2
    v_dot2_f32_bf16 v4, v26, v26, v4
    v_dot2_f32_bf16 v3, v27, s59, v3
    v_dot2_f32_bf16 v5, v27, v27, v5
    v_dot2_f32_bf16 v2, v28, s59, v2
    v_dot2_f32_bf16 v4, v28, v28, v4
    v_dot2_f32_bf16 v3, v29, s59, v3
    v_dot2_f32_bf16 v5, v29, v29, v5
    v_dot2_f32_bf16 v2, v30, s59, v2
    v_dot2_f32_bf16 v4, v30, v30, v4
    v_dot2_f32_bf16 v3, v31, s59, v3
    v_dot2_f32_bf16 v5, v31, v31, v5
    v_dot2_f32_bf16 v2, v32, s59, v2
    v_dot2_f32_bf16 v4, v32, v32, v4
    v_dot2_f32_bf16 v3, v33, s59, v3
    v_dot2_f32_bf16 v5, v33, v33, v5
    v_dot2_f32_bf16 v2, v34, s59, v2
    v_dot2_f32_bf16 v4, v34, v34, v4
    v_dot2_f32_bf16 v3, v35, s59, v3
    v_dot2_f32_bf16 v5, v35, v35, v5
    v_dot2_f32_bf16 v2, v36, s59, v2
    v_dot2_f32_bf16 v4, v36, v36, v4
    v_dot2_f32_bf16 v3, v37, s59, v3
    v_dot2_f32_bf16 v5, v37, v37, v5
    v_dot2_f32_bf16 v2, v38, s59, v2
    v_dot2_f32_bf16 v4, v38, v38, v4
    v_dot2_f32_bf16 v3, v39, s59, v3
    v_dot2_f32_bf16 v5, v39, v39, v5
    s_waitcnt lgkmcnt(0)
    s_barrier
    ds_read_b128 v[40:43], v216 offset:32768
    ds_read_b64_tr_b16 v[184:185], v220 offset:24576
    ds_read_b64_tr_b16 v[186:187], v220 offset:25344
    v_mfma_f32_32x32x16_bf16 v[136:151], v[208:211], v[36:39], v[136:151]
    ds_read_b64_tr_b16 v[188:189], v220 offset:24640
    ds_read_b64_tr_b16 v[190:191], v220 offset:25408
    v_mfma_f32_32x32x16_bf16 v[152:167], v[212:215], v[36:39], v[152:167]
    ds_read_b64_tr_b16 v[192:193], v220 offset:24704
    ds_read_b64_tr_b16 v[194:195], v220 offset:25472
    s_waitcnt lgkmcnt(4)
    v_mfma_f32_32x32x16_bf16 v[120:135], v[184:187], v[40:43], v[120:135]
    ds_read_b128 v[44:47], v217 offset:32768
    ds_read_b64_tr_b16 v[196:197], v220 offset:27648
    ds_read_b64_tr_b16 v[198:199], v220 offset:28416
    s_waitcnt lgkmcnt(5)
    v_mfma_f32_32x32x16_bf16 v[136:151], v[188:191], v[40:43], v[136:151]
    ds_read_b64_tr_b16 v[200:201], v220 offset:27712
    ds_read_b64_tr_b16 v[202:203], v220 offset:28480
    s_waitcnt lgkmcnt(5)
    v_mfma_f32_32x32x16_bf16 v[152:167], v[192:195], v[40:43], v[152:167]
    ds_read_b64_tr_b16 v[204:205], v220 offset:27776
    ds_read_b64_tr_b16 v[206:207], v220 offset:28544
    s_waitcnt lgkmcnt(4)
    v_mfma_f32_32x32x16_bf16 v[120:135], v[196:199], v[44:47], v[120:135]
    ds_read_b128 v[48:51], v218 offset:32768
    ds_read_b64_tr_b16 v[208:209], v220 offset:30720
    ds_read_b64_tr_b16 v[210:211], v220 offset:31488
    s_waitcnt lgkmcnt(5)
    v_mfma_f32_32x32x16_bf16 v[136:151], v[200:203], v[44:47], v[136:151]
    ds_read_b64_tr_b16 v[212:213], v220 offset:30784
    ds_read_b64_tr_b16 v[214:215], v220 offset:31552
    s_waitcnt lgkmcnt(5)
    v_mfma_f32_32x32x16_bf16 v[152:167], v[204:207], v[44:47], v[152:167]
    ds_read_b64_tr_b16 v[184:185], v220 offset:30848
    ds_read_b64_tr_b16 v[186:187], v220 offset:31616
    s_waitcnt lgkmcnt(4)
    v_mfma_f32_32x32x16_bf16 v[120:135], v[208:211], v[48:51], v[120:135]
    ds_read_b128 v[52:55], v219 offset:32768
    ds_read_b64_tr_b16 v[188:189], v220 offset:33792
    ds_read_b64_tr_b16 v[190:191], v220 offset:34560
    s_waitcnt lgkmcnt(5)
    v_mfma_f32_32x32x16_bf16 v[136:151], v[212:215], v[48:51], v[136:151]
    ds_read_b64_tr_b16 v[192:193], v220 offset:33856
    ds_read_b64_tr_b16 v[194:195], v220 offset:34624
    s_waitcnt lgkmcnt(5)
    v_mfma_f32_32x32x16_bf16 v[152:167], v[184:187], v[48:51], v[152:167]
    ds_read_b64_tr_b16 v[196:197], v220 offset:33920
    ds_read_b64_tr_b16 v[198:199], v220 offset:34688
    s_waitcnt lgkmcnt(4)
    v_mfma_f32_32x32x16_bf16 v[120:135], v[188:191], v[52:55], v[120:135]
    v_dot2_f32_bf16 v2, v40, s59, v2
    v_dot2_f32_bf16 v4, v40, v40, v4
    v_dot2_f32_bf16 v3, v41, s59, v3
    v_dot2_f32_bf16 v5, v41, v41, v5
    v_dot2_f32_bf16 v2, v42, s59, v2
    v_dot2_f32_bf16 v4, v42, v42, v4
    v_dot2_f32_bf16 v3, v43, s59, v3
    v_dot2_f32_bf16 v5, v43, v43, v5
    v_dot2_f32_bf16 v2, v44, s59, v2
    v_dot2_f32_bf16 v4, v44, v44, v4
    v_dot2_f32_bf16 v3, v45, s59, v3
    v_dot2_f32_bf16 v5, v45, v45, v5
    v_dot2_f32_bf16 v2, v46, s59, v2
    v_dot2_f32_bf16 v4, v46, v46, v4
    v_dot2_f32_bf16 v3, v47, s59, v3
    v_dot2_f32_bf16 v5, v47, v47, v5
    v_dot2_f32_bf16 v2, v48, s59, v2
    v_dot2_f32_bf16 v4, v48, v48, v4
    v_dot2_f32_bf16 v3, v49, s59, v3
    v_dot2_f32_bf16 v5, v49, v49, v5
    v_dot2_f32_bf16 v2, v50, s59, v2
    v_dot2_f32_bf16 v4, v50, v50, v4
    v_dot2_f32_bf16 v3, v51, s59, v3
    v_dot2_f32_bf16 v5, v51, v51, v5
    v_dot2_f32_bf16 v2, v52, s59, v2
    v_dot2_f32_bf16 v4, v52, v52, v4
    v_dot2_f32_bf16 v3, v53, s59, v3
    v_dot2_f32_bf16 v5, v53, v53, v5
    v_dot2_f32_bf16 v2, v54, s59, v2
    v_dot2_f32_bf16 v4, v54, v54, v4
    v_dot2_f32_bf16 v3, v55, s59, v3
    v_dot2_f32_bf16 v5, v55, v55, v5
    s_waitcnt lgkmcnt(0)
    s_barrier
    ds_read_b128 v[56:59], v216 offset:49152
    ds_read_b64_tr_b16 v[200:201], v220 offset:36864
    ds_read_b64_tr_b16 v[202:203], v220 offset:37632
    v_mfma_f32_32x32x16_bf16 v[136:151], v[192:195], v[52:55], v[136:151]
    ds_read_b64_tr_b16 v[204:205], v220 offset:36928
    ds_read_b64_tr_b16 v[206:207], v220 offset:37696
    v_mfma_f32_32x32x16_bf16 v[152:167], v[196:199], v[52:55], v[152:167]
    ds_read_b64_tr_b16 v[208:209], v220 offset:36992
    ds_read_b64_tr_b16 v[210:211], v220 offset:37760
    s_waitcnt lgkmcnt(4)
    v_mfma_f32_32x32x16_bf16 v[120:135], v[200:203], v[56:59], v[120:135]
    ds_read_b128 v[60:63], v217 offset:49152
    ds_read_b64_tr_b16 v[212:213], v220 offset:39936
    ds_read_b64_tr_b16 v[214:215], v220 offset:40704
    s_waitcnt lgkmcnt(5)
    v_mfma_f32_32x32x16_bf16 v[136:151], v[204:207], v[56:59], v[136:151]
    ds_read_b64_tr_b16 v[184:185], v220 offset:40000
    ds_read_b64_tr_b16 v[186:187], v220 offset:40768
    s_waitcnt lgkmcnt(5)
    v_mfma_f32_32x32x16_bf16 v[152:167], v[208:211], v[56:59], v[152:167]
    ds_read_b64_tr_b16 v[188:189], v220 offset:40064
    ds_read_b64_tr_b16 v[190:191], v220 offset:40832
    s_waitcnt lgkmcnt(4)
    v_mfma_f32_32x32x16_bf16 v[120:135], v[212:215], v[60:63], v[120:135]
    ds_read_b128 v[64:67], v218 offset:49152
    ds_read_b64_tr_b16 v[192:193], v220 offset:43008
    ds_read_b64_tr_b16 v[194:195], v220 offset:43776
    s_waitcnt lgkmcnt(5)
    v_mfma_f32_32x32x16_bf16 v[136:151], v[184:187], v[60:63], v[136:151]
    ds_read_b64_tr_b16 v[196:197], v220 offset:43072
    ds_read_b64_tr_b16 v[198:199], v220 offset:43840
    s_waitcnt lgkmcnt(5)
    v_mfma_f32_32x32x16_bf16 v[152:167], v[188:191], v[60:63], v[152:167]
    ds_read_b64_tr_b16 v[200:201], v220 offset:43136
    ds_read_b64_tr_b16 v[202:203], v220 offset:43904
    s_waitcnt lgkmcnt(4)
    v_mfma_f32_32x32x16_bf16 v[120:135], v[192:195], v[64:67], v[120:135]
    ds_read_b128 v[68:71], v219 offset:49152
    ds_read_b64_tr_b16 v[204:205], v220 offset:46080
    ds_read_b64_tr_b16 v[206:207], v220 offset:46848
    s_waitcnt lgkmcnt(5)
    v_mfma_f32_32x32x16_bf16 v[136:151], v[196:199], v[64:67], v[136:151]
    ds_read_b64_tr_b16 v[208:209], v220 offset:46144
    ds_read_b64_tr_b16 v[210:211], v220 offset:46912
    s_waitcnt lgkmcnt(5)
    v_mfma_f32_32x32x16_bf16 v[152:167], v[200:203], v[64:67], v[152:167]
    ds_read_b64_tr_b16 v[212:213], v220 offset:46208
    ds_read_b64_tr_b16 v[214:215], v220 offset:46976
    s_waitcnt lgkmcnt(4)
    v_mfma_f32_32x32x16_bf16 v[120:135], v[204:207], v[68:71], v[120:135]
    v_dot2_f32_bf16 v2, v56, s59, v2
    v_dot2_f32_bf16 v4, v56, v56, v4
    v_dot2_f32_bf16 v3, v57, s59, v3
    v_dot2_f32_bf16 v5, v57, v57, v5
    v_dot2_f32_bf16 v2, v58, s59, v2
    v_dot2_f32_bf16 v4, v58, v58, v4
    v_dot2_f32_bf16 v3, v59, s59, v3
    v_dot2_f32_bf16 v5, v59, v59, v5
    v_dot2_f32_bf16 v2, v60, s59, v2
    v_dot2_f32_bf16 v4, v60, v60, v4
    v_dot2_f32_bf16 v3, v61, s59, v3
    v_dot2_f32_bf16 v5, v61, v61, v5
    v_dot2_f32_bf16 v2, v62, s59, v2
    v_dot2_f32_bf16 v4, v62, v62, v4
    v_dot2_f32_bf16 v3, v63, s59, v3
    v_dot2_f32_bf16 v5, v63, v63, v5
    v_dot2_f32_bf16 v2, v64, s59, v2
    v_dot2_f32_bf16 v4, v64, v64, v4
    v_dot2_f32_bf16 v3, v65, s59, v3
    v_dot2_f32_bf16 v5, v65, v65, v5
    v_dot2_f32_bf16 v2, v66, s59, v2
    v_dot2_f32_bf16 v4, v66, v66, v4
    v_dot2_f32_bf16 v3, v67, s59, v3
    v_dot2_f32_bf16 v5, v67, v67, v5
    v_dot2_f32_bf16 v2, v68, s59, v2
    v_dot2_f32_bf16 v4, v68, v68, v4
    v_dot2_f32_bf16 v3, v69, s59, v3
    v_dot2_f32_bf16 v5, v69, v69, v5
    v_dot2_f32_bf16 v2, v70, s59, v2
    v_dot2_f32_bf16 v4, v70, v70, v4
    v_dot2_f32_bf16 v3, v71, s59, v3
    v_dot2_f32_bf16 v5, v71, v71, v5
    s_waitcnt lgkmcnt(0)
    s_barrier
    ds_read_b128 v[72:75], v216 offset:0
    ds_read_b64_tr_b16 v[184:185], v220 offset:0
    ds_read_b64_tr_b16 v[186:187], v220 offset:768
    v_mfma_f32_32x32x16_bf16 v[136:151], v[208:211], v[68:71], v[136:151]
    ds_read_b64_tr_b16 v[188:189], v220 offset:64
    ds_read_b64_tr_b16 v[190:191], v220 offset:832
    v_mfma_f32_32x32x16_bf16 v[152:167], v[212:215], v[68:71], v[152:167]
    ds_read_b64_tr_b16 v[192:193], v220 offset:128
    ds_read_b64_tr_b16 v[194:195], v220 offset:896
    s_waitcnt lgkmcnt(4)
    v_mfma_f32_32x32x16_bf16 v[120:135], v[184:187], v[72:75], v[120:135]
    ds_read_b128 v[76:79], v217 offset:0
    ds_read_b64_tr_b16 v[196:197], v220 offset:3072
    ds_read_b64_tr_b16 v[198:199], v220 offset:3840
    s_waitcnt lgkmcnt(5)
    v_mfma_f32_32x32x16_bf16 v[136:151], v[188:191], v[72:75], v[136:151]
    ds_read_b64_tr_b16 v[200:201], v220 offset:3136
    ds_read_b64_tr_b16 v[202:203], v220 offset:3904
    s_waitcnt lgkmcnt(5)
    v_mfma_f32_32x32x16_bf16 v[152:167], v[192:195], v[72:75], v[152:167]
    ds_read_b64_tr_b16 v[204:205], v220 offset:3200
    ds_read_b64_tr_b16 v[206:207], v220 offset:3968
    s_waitcnt lgkmcnt(4)
    v_mfma_f32_32x32x16_bf16 v[120:135], v[196:199], v[76:79], v[120:135]
    ds_read_b128 v[80:83], v218 offset:0
    ds_read_b64_tr_b16 v[208:209], v220 offset:6144
    ds_read_b64_tr_b16 v[210:211], v220 offset:6912
    s_waitcnt lgkmcnt(5)
    v_mfma_f32_32x32x16_bf16 v[136:151], v[200:203], v[76:79], v[136:151]
    ds_read_b64_tr_b16 v[212:213], v220 offset:6208
    ds_read_b64_tr_b16 v[214:215], v220 offset:6976
    s_waitcnt lgkmcnt(5)
    v_mfma_f32_32x32x16_bf16 v[152:167], v[204:207], v[76:79], v[152:167]
    ds_read_b64_tr_b16 v[184:185], v220 offset:6272
    ds_read_b64_tr_b16 v[186:187], v220 offset:7040
    s_waitcnt lgkmcnt(4)
    v_mfma_f32_32x32x16_bf16 v[120:135], v[208:211], v[80:83], v[120:135]
    ds_read_b128 v[84:87], v219 offset:0
    ds_read_b64_tr_b16 v[188:189], v220 offset:9216
    ds_read_b64_tr_b16 v[190:191], v220 offset:9984
    s_waitcnt lgkmcnt(5)
    v_mfma_f32_32x32x16_bf16 v[136:151], v[212:215], v[80:83], v[136:151]
    ds_read_b64_tr_b16 v[192:193], v220 offset:9280
    ds_read_b64_tr_b16 v[194:195], v220 offset:10048
    s_waitcnt lgkmcnt(5)
    v_mfma_f32_32x32x16_bf16 v[152:167], v[184:187], v[80:83], v[152:167]
    ds_read_b64_tr_b16 v[196:197], v220 offset:9344
    ds_read_b64_tr_b16 v[198:199], v220 offset:10112
    s_waitcnt lgkmcnt(4)
    v_mfma_f32_32x32x16_bf16 v[120:135], v[188:191], v[84:87], v[120:135]
    v_dot2_f32_bf16 v2, v72, s59, v2
    v_dot2_f32_bf16 v4, v72, v72, v4
    v_dot2_f32_bf16 v3, v73, s59, v3
    v_dot2_f32_bf16 v5, v73, v73, v5
    v_dot2_f32_bf16 v2, v74, s59, v2
    v_dot2_f32_bf16 v4, v74, v74, v4
    v_dot2_f32_bf16 v3, v75, s59, v3
    v_dot2_f32_bf16 v5, v75, v75, v5
    v_dot2_f32_bf16 v2, v76, s59, v2
    v_dot2_f32_bf16 v4, v76, v76, v4
    v_dot2_f32_bf16 v3, v77, s59, v3
    v_dot2_f32_bf16 v5, v77, v77, v5
    v_dot2_f32_bf16 v2, v78, s59, v2
    v_dot2_f32_bf16 v4, v78, v78, v4
    v_dot2_f32_bf16 v3, v79, s59, v3
    v_dot2_f32_bf16 v5, v79, v79, v5
    v_dot2_f32_bf16 v2, v80, s59, v2
    v_dot2_f32_bf16 v4, v80, v80, v4
    v_dot2_f32_bf16 v3, v81, s59, v3
    v_dot2_f32_bf16 v5, v81, v81, v5
    v_dot2_f32_bf16 v2, v82, s59, v2
    v_dot2_f32_bf16 v4, v82, v82, v4
    v_dot2_f32_bf16 v3, v83, s59, v3
    v_dot2_f32_bf16 v5, v83, v83, v5
    v_dot2_f32_bf16 v2, v84, s59, v2
    v_dot2_f32_bf16 v4, v84, v84, v4
    v_dot2_f32_bf16 v3, v85, s59, v3
    v_dot2_f32_bf16 v5, v85, v85, v5
    v_dot2_f32_bf16 v2, v86, s59, v2
    v_dot2_f32_bf16 v4, v86, v86, v4
    v_dot2_f32_bf16 v3, v87, s59, v3
    v_dot2_f32_bf16 v5, v87, v87, v5
    s_waitcnt lgkmcnt(0)
    s_barrier
    ds_read_b128 v[88:91], v216 offset:16384
    ds_read_b64_tr_b16 v[200:201], v220 offset:12288
    ds_read_b64_tr_b16 v[202:203], v220 offset:13056
    v_mfma_f32_32x32x16_bf16 v[136:151], v[192:195], v[84:87], v[136:151]
    ds_read_b64_tr_b16 v[204:205], v220 offset:12352
    ds_read_b64_tr_b16 v[206:207], v220 offset:13120
    v_mfma_f32_32x32x16_bf16 v[152:167], v[196:199], v[84:87], v[152:167]
    ds_read_b64_tr_b16 v[208:209], v220 offset:12416
    ds_read_b64_tr_b16 v[210:211], v220 offset:13184
    s_waitcnt lgkmcnt(4)
    v_mfma_f32_32x32x16_bf16 v[120:135], v[200:203], v[88:91], v[120:135]
    ds_read_b128 v[92:95], v217 offset:16384
    ds_read_b64_tr_b16 v[212:213], v220 offset:15360
    ds_read_b64_tr_b16 v[214:215], v220 offset:16128
    s_waitcnt lgkmcnt(5)
    v_mfma_f32_32x32x16_bf16 v[136:151], v[204:207], v[88:91], v[136:151]
    ds_read_b64_tr_b16 v[184:185], v220 offset:15424
    ds_read_b64_tr_b16 v[186:187], v220 offset:16192
    s_waitcnt lgkmcnt(5)
    v_mfma_f32_32x32x16_bf16 v[152:167], v[208:211], v[88:91], v[152:167]
    ds_read_b64_tr_b16 v[188:189], v220 offset:15488
    ds_read_b64_tr_b16 v[190:191], v220 offset:16256
    s_waitcnt lgkmcnt(4)
    v_mfma_f32_32x32x16_bf16 v[120:135], v[212:215], v[92:95], v[120:135]
    ds_read_b128 v[96:99], v218 offset:16384
    ds_read_b64_tr_b16 v[192:193], v220 offset:18432
    ds_read_b64_tr_b16 v[194:195], v220 offset:19200
    s_waitcnt lgkmcnt(5)
    v_mfma_f32_32x32x16_bf16 v[136:151], v[184:187], v[92:95], v[136:151]
    ds_read_b64_tr_b16 v[196:197], v220 offset:18496
    ds_read_b64_tr_b16 v[198:199], v220 offset:19264
    s_waitcnt lgkmcnt(5)
    v_mfma_f32_32x32x16_bf16 v[152:167], v[188:191], v[92:95], v[152:167]
    ds_read_b64_tr_b16 v[200:201], v220 offset:18560
    ds_read_b64_tr_b16 v[202:203], v220 offset:19328
    s_waitcnt lgkmcnt(4)
    v_mfma_f32_32x32x16_bf16 v[120:135], v[192:195], v[96:99], v[120:135]
    ds_read_b128 v[100:103], v219 offset:16384
    ds_read_b64_tr_b16 v[204:205], v220 offset:21504
    ds_read_b64_tr_b16 v[206:207], v220 offset:22272
    s_waitcnt lgkmcnt(5)
    v_mfma_f32_32x32x16_bf16 v[136:151], v[196:199], v[96:99], v[136:151]
    ds_read_b64_tr_b16 v[208:209], v220 offset:21568
    ds_read_b64_tr_b16 v[210:211], v220 offset:22336
    s_waitcnt lgkmcnt(5)
    v_mfma_f32_32x32x16_bf16 v[152:167], v[200:203], v[96:99], v[152:167]
    ds_read_b64_tr_b16 v[212:213], v220 offset:21632
    ds_read_b64_tr_b16 v[214:215], v220 offset:22400
    s_waitcnt lgkmcnt(4)
    v_mfma_f32_32x32x16_bf16 v[120:135], v[204:207], v[100:103], v[120:135]
    v_dot2_f32_bf16 v2, v88, s59, v2
    v_dot2_f32_bf16 v4, v88, v88, v4
    v_dot2_f32_bf16 v3, v89, s59, v3
    v_dot2_f32_bf16 v5, v89, v89, v5
    v_dot2_f32_bf16 v2, v90, s59, v2
    v_dot2_f32_bf16 v4, v90, v90, v4
    v_dot2_f32_bf16 v3, v91, s59, v3
    v_dot2_f32_bf16 v5, v91, v91, v5
    v_dot2_f32_bf16 v2, v92, s59, v2
    v_dot2_f32_bf16 v4, v92, v92, v4
    v_dot2_f32_bf16 v3, v93, s59, v3
    v_dot2_f32_bf16 v5, v93, v93, v5
    v_dot2_f32_bf16 v2, v94, s59, v2
    v_dot2_f32_bf16 v4, v94, v94, v4
    v_dot2_f32_bf16 v3, v95, s59, v3
    v_dot2_f32_bf16 v5, v95, v95, v5
    v_dot2_f32_bf16 v2, v96, s59, v2
    v_dot2_f32_bf16 v4, v96, v96, v4
    v_dot2_f32_bf16 v3, v97, s59, v3
    v_dot2_f32_bf16 v5, v97, v97, v5
    v_dot2_f32_bf16 v2, v98, s59, v2
    v_dot2_f32_bf16 v4, v98, v98, v4
    v_dot2_f32_bf16 v3, v99, s59, v3
    v_dot2_f32_bf16 v5, v99, v99, v5
    v_dot2_f32_bf16 v2, v100, s59, v2
    v_dot2_f32_bf16 v4, v100, v100, v4
    v_dot2_f32_bf16 v3, v101, s59, v3
    v_dot2_f32_bf16 v5, v101, v101, v5
    v_dot2_f32_bf16 v2, v102, s59, v2
    v_dot2_f32_bf16 v4, v102, v102, v4
    v_dot2_f32_bf16 v3, v103, s59, v3
    v_dot2_f32_bf16 v5, v103, v103, v5
    s_waitcnt lgkmcnt(0)
    s_barrier
    ds_read_b128 v[104:107], v216 offset:32768
    ds_read_b128 v[108:111], v217 offset:32768
    ds_read_b128 v[112:115], v218 offset:32768
    ds_read_b128 v[116:119], v219 offset:32768
    ds_read_b64_tr_b16 v[184:185], v220 offset:24576
    ds_read_b64_tr_b16 v[186:187], v220 offset:25344
    v_mfma_f32_32x32x16_bf16 v[136:151], v[208:211], v[100:103], v[136:151]
    ds_read_b64_tr_b16 v[188:189], v220 offset:24640
    ds_read_b64_tr_b16 v[190:191], v220 offset:25408
    v_mfma_f32_32x32x16_bf16 v[152:167], v[212:215], v[100:103], v[152:167]
    ds_read_b64_tr_b16 v[192:193], v220 offset:24704
    ds_read_b64_tr_b16 v[194:195], v220 offset:25472
    s_waitcnt lgkmcnt(6)
    v_dot2_f32_bf16 v2, v104, s59, v2
    v_dot2_f32_bf16 v4, v104, v104, v4
    v_dot2_f32_bf16 v3, v105, s59, v3
    v_dot2_f32_bf16 v5, v105, v105, v5
    v_dot2_f32_bf16 v2, v106, s59, v2
    v_dot2_f32_bf16 v4, v106, v106, v4
    v_dot2_f32_bf16 v3, v107, s59, v3
    v_dot2_f32_bf16 v5, v107, v107, v5
    v_dot2_f32_bf16 v2, v108, s59, v2
    v_dot2_f32_bf16 v4, v108, v108, v4
    v_dot2_f32_bf16 v3, v109, s59, v3
    v_dot2_f32_bf16 v5, v109, v109, v5
    v_dot2_f32_bf16 v2, v110, s59, v2
    v_dot2_f32_bf16 v4, v110, v110, v4
    v_dot2_f32_bf16 v3, v111, s59, v3
    v_dot2_f32_bf16 v5, v111, v111, v5
    v_dot2_f32_bf16 v2, v112, s59, v2
    v_dot2_f32_bf16 v4, v112, v112, v4
    v_dot2_f32_bf16 v3, v113, s59, v3
    v_dot2_f32_bf16 v5, v113, v113, v5
    v_dot2_f32_bf16 v2, v114, s59, v2
    v_dot2_f32_bf16 v4, v114, v114, v4
    v_dot2_f32_bf16 v3, v115, s59, v3
    v_dot2_f32_bf16 v5, v115, v115, v5
    v_dot2_f32_bf16 v2, v116, s59, v2
    v_dot2_f32_bf16 v4, v116, v116, v4
    v_dot2_f32_bf16 v3, v117, s59, v3
    v_dot2_f32_bf16 v5, v117, v117, v5
    v_dot2_f32_bf16 v2, v118, s59, v2
    v_dot2_f32_bf16 v4, v118, v118, v4
    v_dot2_f32_bf16 v3, v119, s59, v3
    v_dot2_f32_bf16 v5, v119, v119, v5
    s_waitcnt lgkmcnt(4)
    v_mfma_f32_32x32x16_bf16 v[120:135], v[184:187], v[104:107], v[120:135]
    ds_read_b64_tr_b16 v[196:197], v220 offset:27648
    ds_read_b64_tr_b16 v[198:199], v220 offset:28416
    v_add_f32 v2, v2, v3
    v_add_f32 v4, v4, v5
    s_waitcnt lgkmcnt(4)
    v_mfma_f32_32x32x16_bf16 v[136:151], v[188:191], v[104:107], v[136:151]
    ds_read_b64_tr_b16 v[200:201], v220 offset:27712
    ds_read_b64_tr_b16 v[202:203], v220 offset:28480
    v_permlane32_swap_b32 v2, v4
    v_add_f32 v2, v2, v4
    s_waitcnt lgkmcnt(4)
    v_mfma_f32_32x32x16_bf16 v[152:167], v[192:195], v[104:107], v[152:167]
    ds_read_b64_tr_b16 v[204:205], v220 offset:27776
    ds_read_b64_tr_b16 v[206:207], v220 offset:28544
    v_mov_b32 v4, v2
    s_nop 1
    v_permlane32_swap_b32 v2, v4
    s_waitcnt lgkmcnt(4)
    v_mfma_f32_32x32x16_bf16 v[120:135], v[196:199], v[108:111], v[120:135]
    ds_read_b64_tr_b16 v[208:209], v220 offset:30720
    ds_read_b64_tr_b16 v[210:211], v220 offset:31488
    v_mul_f32 v2, 0xbb124925, v2
    v_mul_f32 v4, 0x3b124925, v4
    s_waitcnt lgkmcnt(4)
    v_mfma_f32_32x32x16_bf16 v[136:151], v[200:203], v[108:111], v[136:151]
    ds_read_b64_tr_b16 v[212:213], v220 offset:30784
    ds_read_b64_tr_b16 v[214:215], v220 offset:31552
    v_cvt_pk_bf16_f32 v236, v2, v2
    v_fma_f32 v4, -v2, v2, v4
    s_waitcnt lgkmcnt(4)
    v_mfma_f32_32x32x16_bf16 v[152:167], v[204:207], v[108:111], v[152:167]
    ds_read_b64_tr_b16 v[184:185], v220 offset:30848
    ds_read_b64_tr_b16 v[186:187], v220 offset:31616
    v_and_b32 v237, 0xffff0000, v236
    v_max_f32 v4, 0, v4
    s_waitcnt lgkmcnt(4)
    v_mfma_f32_32x32x16_bf16 v[120:135], v[208:211], v[112:115], v[120:135]
    ds_read_b64_tr_b16 v[188:189], v220 offset:33792
    ds_read_b64_tr_b16 v[190:191], v220 offset:34560
    v_sub_f32 v237, v2, v237
    v_add_f32 v4, 0x3727c5ac, v4
    s_waitcnt lgkmcnt(4)
    v_mfma_f32_32x32x16_bf16 v[136:151], v[212:215], v[112:115], v[136:151]
    ds_read_b64_tr_b16 v[192:193], v220 offset:33856
    ds_read_b64_tr_b16 v[194:195], v220 offset:34624
    v_cvt_pk_bf16_f32 v236, v2, v237
    v_rsq_f32 v228, v4
    s_waitcnt lgkmcnt(4)
    v_mfma_f32_32x32x16_bf16 v[152:167], v[184:187], v[112:115], v[152:167]
    ds_read_b64_tr_b16 v[196:197], v220 offset:33920
    ds_read_b64_tr_b16 v[198:199], v220 offset:34688
    v_mov_b32 v237, v236
    v_mov_b32 v238, v236
    s_waitcnt lgkmcnt(4)
    v_mfma_f32_32x32x16_bf16 v[120:135], v[188:191], v[116:119], v[120:135]
    v_mov_b32 v239, v236
    v_sqrt_f32 v230, v4
    s_waitcnt lgkmcnt(2)
    v_mfma_f32_32x32x16_bf16 v[136:151], v[192:195], v[116:119], v[136:151]
    v_mul_f32 v232, 0xbfb8aa3b, v228
    v_mul_f32 v244, s4, v228
    s_waitcnt lgkmcnt(0)
    v_mfma_f32_32x32x16_bf16 v[152:167], v[196:199], v[116:119], v[152:167]
    v_mul_f32 v246, s5, v228
    v_mul_f32 v248, s6, v228
    v_mov_b32 v6, 161808
    v_add_u32 v216, 0x20000, v221
    v_add_u32 v217, 0x20000, v222
    s_barrier
    ds_read_b32 v6, v6
    ds_read_b64 v[168:169], v240 offset:0
    ds_read_b64 v[172:173], v240 offset:512
    ds_read_b64 v[176:177], v240 offset:1024
    s_waitcnt lgkmcnt(0)
    v_mfma_f32_32x32x16_bf16 v[120:135], v[168:171], v[236:239], v[120:135]
    v_mfma_f32_32x32x16_bf16 v[136:151], v[172:175], v[236:239], v[136:151]
    v_mfma_f32_32x32x16_bf16 v[152:167], v[176:179], v[236:239], v[152:167]
    ds_read_b64_tr_b16 v[184:185], v224 offset:49152
    ds_read_b64_tr_b16 v[186:187], v224 offset:49664
    ds_read_b64_tr_b16 v[188:189], v225 offset:49152
    ds_read_b64_tr_b16 v[190:191], v225 offset:49664
    ds_read_b64_tr_b16 v[192:193], v224 offset:51200
    ds_read_b64_tr_b16 v[194:195], v224 offset:51712
    ds_read_b64_tr_b16 v[196:197], v225 offset:51200
    ds_read_b64_tr_b16 v[198:199], v225 offset:51712
    s_nop 1
    v_pk_mul_f32 v[120:121], v[120:121], v[244:245] op_sel_hi:[1,0]
    v_pk_mul_f32 v[122:123], v[122:123], v[244:245] op_sel_hi:[1,0]
    v_pk_mul_f32 v[124:125], v[124:125], v[244:245] op_sel_hi:[1,0]
    v_pk_mul_f32 v[126:127], v[126:127], v[244:245] op_sel_hi:[1,0]
    v_pk_mul_f32 v[128:129], v[128:129], v[244:245] op_sel_hi:[1,0]
    v_pk_mul_f32 v[130:131], v[130:131], v[244:245] op_sel_hi:[1,0]
    v_pk_mul_f32 v[132:133], v[132:133], v[244:245] op_sel_hi:[1,0]
    v_pk_mul_f32 v[134:135], v[134:135], v[244:245] op_sel_hi:[1,0]
    v_cvt_pk_bf16_f32 v120, v120, v121
    v_cvt_pk_bf16_f32 v121, v122, v123
    v_cvt_pk_bf16_f32 v122, v124, v125
    v_cvt_pk_bf16_f32 v123, v126, v127
    v_cvt_pk_bf16_f32 v124, v128, v129
    v_cvt_pk_bf16_f32 v125, v130, v131
    v_cvt_pk_bf16_f32 v126, v132, v133
    v_cvt_pk_bf16_f32 v127, v134, v135
    buffer_store_dwordx4 v[120:123], v242, s[36:39], s55 offen offset:0 sc1
    v_pk_mul_f32 v[136:137], v[136:137], v[246:247] op_sel_hi:[1,0]
    v_pk_mul_f32 v[138:139], v[138:139], v[246:247] op_sel_hi:[1,0]
    v_pk_mul_f32 v[140:141], v[140:141], v[246:247] op_sel_hi:[1,0]
    v_pk_mul_f32 v[142:143], v[142:143], v[246:247] op_sel_hi:[1,0]
    v_pk_mul_f32 v[144:145], v[144:145], v[246:247] op_sel_hi:[1,0]
    v_pk_mul_f32 v[146:147], v[146:147], v[246:247] op_sel_hi:[1,0]
    v_pk_mul_f32 v[148:149], v[148:149], v[246:247] op_sel_hi:[1,0]
    v_pk_mul_f32 v[150:151], v[150:151], v[246:247] op_sel_hi:[1,0]
    v_cvt_pk_bf16_f32 v128, v136, v137
    v_cvt_pk_bf16_f32 v129, v138, v139
    v_cvt_pk_bf16_f32 v130, v140, v141
    v_cvt_pk_bf16_f32 v131, v142, v143
    v_cvt_pk_bf16_f32 v132, v144, v145
    v_cvt_pk_bf16_f32 v133, v146, v147
    v_cvt_pk_bf16_f32 v134, v148, v149
    v_cvt_pk_bf16_f32 v135, v150, v151
    v_pk_mul_f32 v[152:153], v[152:153], v[248:249] op_sel_hi:[1,0]
    v_pk_mul_f32 v[154:155], v[154:155], v[248:249] op_sel_hi:[1,0]
    v_pk_mul_f32 v[156:157], v[156:157], v[248:249] op_sel_hi:[1,0]
    v_pk_mul_f32 v[158:159], v[158:159], v[248:249] op_sel_hi:[1,0]
    v_pk_mul_f32 v[160:161], v[160:161], v[248:249] op_sel_hi:[1,0]
    v_pk_mul_f32 v[162:163], v[162:163], v[248:249] op_sel_hi:[1,0]
    v_pk_mul_f32 v[164:165], v[164:165], v[248:249] op_sel_hi:[1,0]
    v_pk_mul_f32 v[166:167], v[166:167], v[248:249] op_sel_hi:[1,0]
    v_cvt_pk_bf16_f32 v136, v152, v153
    v_cvt_pk_bf16_f32 v137, v154, v155
    v_cvt_pk_bf16_f32 v138, v156, v157
    v_cvt_pk_bf16_f32 v139, v158, v159
    v_cvt_pk_bf16_f32 v140, v160, v161
    v_cvt_pk_bf16_f32 v141, v162, v163
    v_cvt_pk_bf16_f32 v142, v164, v165
    v_cvt_pk_bf16_f32 v143, v166, v167
    buffer_store_dwordx4 v[124:127], v243, s[36:39], s55 offen offset:0 sc1
    s_waitcnt lgkmcnt(6)
    v_mfma_f32_32x32x16_bf16 v[152:167], v[184:187], v[8:11], 0
    ds_read_b64_tr_b16 v[200:201], v224 offset:53248
    ds_read_b64_tr_b16 v[202:203], v224 offset:53760
    s_waitcnt lgkmcnt(6)
    v_mfma_f32_32x32x16_bf16 v[168:183], v[188:191], v[8:11], 0
    ds_read_b64_tr_b16 v[204:205], v225 offset:53248
    ds_read_b64_tr_b16 v[206:207], v225 offset:53760
    s_waitcnt lgkmcnt(6)
    v_mfma_f32_32x32x16_bf16 v[152:167], v[192:195], v[12:15], v[152:167]
    ds_read_b64_tr_b16 v[208:209], v224 offset:55296
    ds_read_b64_tr_b16 v[210:211], v224 offset:55808
    s_waitcnt lgkmcnt(6)
    v_mfma_f32_32x32x16_bf16 v[168:183], v[196:199], v[12:15], v[168:183]
    ds_read_b64_tr_b16 v[212:213], v225 offset:55296
    ds_read_b64_tr_b16 v[214:215], v225 offset:55808
    s_waitcnt lgkmcnt(6)
    v_mfma_f32_32x32x16_bf16 v[152:167], v[200:203], v[16:19], v[152:167]
    ds_read_b64_tr_b16 v[184:185], v224 offset:57344
    ds_read_b64_tr_b16 v[186:187], v224 offset:57856
    s_waitcnt lgkmcnt(6)
    v_mfma_f32_32x32x16_bf16 v[168:183], v[204:207], v[16:19], v[168:183]
    ds_read_b64_tr_b16 v[188:189], v225 offset:57344
    ds_read_b64_tr_b16 v[190:191], v225 offset:57856
    s_waitcnt lgkmcnt(6)
    v_mfma_f32_32x32x16_bf16 v[152:167], v[208:211], v[20:23], v[152:167]
    ds_read_b64_tr_b16 v[192:193], v224 offset:59392
    ds_read_b64_tr_b16 v[194:195], v224 offset:59904
    s_waitcnt lgkmcnt(6)
    v_mfma_f32_32x32x16_bf16 v[168:183], v[212:215], v[20:23], v[168:183]
    ds_read_b64_tr_b16 v[196:197], v225 offset:59392
    ds_read_b64_tr_b16 v[198:199], v225 offset:59904
    buffer_store_dwordx4 v[128:131], v242, s[36:39], s55 offen offset:2048 sc1
    s_waitcnt lgkmcnt(6)
    v_mfma_f32_32x32x16_bf16 v[152:167], v[184:187], v[24:27], v[152:167]
    ds_read_b64_tr_b16 v[200:201], v224 offset:61440
    ds_read_b64_tr_b16 v[202:203], v224 offset:61952
    s_waitcnt lgkmcnt(6)
    v_mfma_f32_32x32x16_bf16 v[168:183], v[188:191], v[24:27], v[168:183]
    ds_read_b64_tr_b16 v[204:205], v225 offset:61440
    ds_read_b64_tr_b16 v[206:207], v225 offset:61952
    s_waitcnt lgkmcnt(6)
    v_mfma_f32_32x32x16_bf16 v[152:167], v[192:195], v[28:31], v[152:167]
    ds_read_b64_tr_b16 v[208:209], v224 offset:63488
    ds_read_b64_tr_b16 v[210:211], v224 offset:64000
    s_waitcnt lgkmcnt(6)
    v_mfma_f32_32x32x16_bf16 v[168:183], v[196:199], v[28:31], v[168:183]
    ds_read_b64_tr_b16 v[212:213], v225 offset:63488
    ds_read_b64_tr_b16 v[214:215], v225 offset:64000
    s_waitcnt lgkmcnt(6)
    v_mfma_f32_32x32x16_bf16 v[152:167], v[200:203], v[32:35], v[152:167]
    ds_read_b64_tr_b16 v[184:185], v216 offset:0
    ds_read_b64_tr_b16 v[186:187], v216 offset:512
    s_waitcnt lgkmcnt(6)
    v_mfma_f32_32x32x16_bf16 v[168:183], v[204:207], v[32:35], v[168:183]
    ds_read_b64_tr_b16 v[188:189], v217 offset:0
    ds_read_b64_tr_b16 v[190:191], v217 offset:512
    s_waitcnt lgkmcnt(6)
    v_mfma_f32_32x32x16_bf16 v[152:167], v[208:211], v[36:39], v[152:167]
    ds_read_b64_tr_b16 v[192:193], v216 offset:2048
    ds_read_b64_tr_b16 v[194:195], v216 offset:2560
    s_waitcnt lgkmcnt(6)
    v_mfma_f32_32x32x16_bf16 v[168:183], v[212:215], v[36:39], v[168:183]
    ds_read_b64_tr_b16 v[196:197], v217 offset:2048
    ds_read_b64_tr_b16 v[198:199], v217 offset:2560
    buffer_store_dwordx4 v[132:135], v243, s[36:39], s55 offen offset:2048 sc1
    s_waitcnt lgkmcnt(6)
    v_mfma_f32_32x32x16_bf16 v[152:167], v[184:187], v[40:43], v[152:167]
    ds_read_b64_tr_b16 v[200:201], v216 offset:4096
    ds_read_b64_tr_b16 v[202:203], v216 offset:4608
    s_waitcnt lgkmcnt(6)
    v_mfma_f32_32x32x16_bf16 v[168:183], v[188:191], v[40:43], v[168:183]
    ds_read_b64_tr_b16 v[204:205], v217 offset:4096
    ds_read_b64_tr_b16 v[206:207], v217 offset:4608
    s_waitcnt lgkmcnt(6)
    v_mfma_f32_32x32x16_bf16 v[152:167], v[192:195], v[44:47], v[152:167]
    ds_read_b64_tr_b16 v[208:209], v216 offset:6144
    ds_read_b64_tr_b16 v[210:211], v216 offset:6656
    s_waitcnt lgkmcnt(6)
    v_mfma_f32_32x32x16_bf16 v[168:183], v[196:199], v[44:47], v[168:183]
    ds_read_b64_tr_b16 v[212:213], v217 offset:6144
    ds_read_b64_tr_b16 v[214:215], v217 offset:6656
    s_waitcnt lgkmcnt(6)
    v_mfma_f32_32x32x16_bf16 v[152:167], v[200:203], v[48:51], v[152:167]
    ds_read_b64_tr_b16 v[184:185], v216 offset:8192
    ds_read_b64_tr_b16 v[186:187], v216 offset:8704
    s_waitcnt lgkmcnt(6)
    v_mfma_f32_32x32x16_bf16 v[168:183], v[204:207], v[48:51], v[168:183]
    ds_read_b64_tr_b16 v[188:189], v217 offset:8192
    ds_read_b64_tr_b16 v[190:191], v217 offset:8704
    s_waitcnt lgkmcnt(6)
    v_mfma_f32_32x32x16_bf16 v[152:167], v[208:211], v[52:55], v[152:167]
    ds_read_b64_tr_b16 v[192:193], v216 offset:10240
    ds_read_b64_tr_b16 v[194:195], v216 offset:10752
    s_waitcnt lgkmcnt(6)
    v_mfma_f32_32x32x16_bf16 v[168:183], v[212:215], v[52:55], v[168:183]
    ds_read_b64_tr_b16 v[196:197], v217 offset:10240
    ds_read_b64_tr_b16 v[198:199], v217 offset:10752
    buffer_store_dwordx4 v[136:139], v242, s[36:39], s56 offen offset:0 sc1
    s_waitcnt lgkmcnt(6)
    v_mfma_f32_32x32x16_bf16 v[152:167], v[184:187], v[56:59], v[152:167]
    ds_read_b64_tr_b16 v[200:201], v216 offset:12288
    ds_read_b64_tr_b16 v[202:203], v216 offset:12800
    s_waitcnt lgkmcnt(6)
    v_mfma_f32_32x32x16_bf16 v[168:183], v[188:191], v[56:59], v[168:183]
    ds_read_b64_tr_b16 v[204:205], v217 offset:12288
    ds_read_b64_tr_b16 v[206:207], v217 offset:12800
    s_waitcnt lgkmcnt(6)
    v_mfma_f32_32x32x16_bf16 v[152:167], v[192:195], v[60:63], v[152:167]
    ds_read_b64_tr_b16 v[208:209], v216 offset:14336
    ds_read_b64_tr_b16 v[210:211], v216 offset:14848
    s_waitcnt lgkmcnt(6)
    v_mfma_f32_32x32x16_bf16 v[168:183], v[196:199], v[60:63], v[168:183]
    ds_read_b64_tr_b16 v[212:213], v217 offset:14336
    ds_read_b64_tr_b16 v[214:215], v217 offset:14848
    s_waitcnt lgkmcnt(6)
    v_mfma_f32_32x32x16_bf16 v[152:167], v[200:203], v[64:67], v[152:167]
    s_waitcnt lgkmcnt(0)
    s_barrier
    ds_read_b64_tr_b16 v[184:185], v221 offset:0
    ds_read_b64_tr_b16 v[186:187], v221 offset:512
    v_mfma_f32_32x32x16_bf16 v[168:183], v[204:207], v[64:67], v[168:183]
    ds_read_b64_tr_b16 v[188:189], v222 offset:0
    ds_read_b64_tr_b16 v[190:191], v222 offset:512
    v_mfma_f32_32x32x16_bf16 v[152:167], v[208:211], v[68:71], v[152:167]
    ds_read_b64_tr_b16 v[192:193], v221 offset:2048
    ds_read_b64_tr_b16 v[194:195], v221 offset:2560
    v_mfma_f32_32x32x16_bf16 v[168:183], v[212:215], v[68:71], v[168:183]
    ds_read_b64_tr_b16 v[196:197], v222 offset:2048
    ds_read_b64_tr_b16 v[198:199], v222 offset:2560
    buffer_store_dwordx4 v[140:143], v243, s[36:39], s56 offen offset:0 sc1
    s_waitcnt lgkmcnt(6)
    v_mfma_f32_32x32x16_bf16 v[152:167], v[184:187], v[72:75], v[152:167]
    ds_read_b64_tr_b16 v[200:201], v221 offset:4096
    ds_read_b64_tr_b16 v[202:203], v221 offset:4608
    s_waitcnt lgkmcnt(6)
    v_mfma_f32_32x32x16_bf16 v[168:183], v[188:191], v[72:75], v[168:183]
    ds_read_b64_tr_b16 v[204:205], v222 offset:4096
    ds_read_b64_tr_b16 v[206:207], v222 offset:4608
    s_waitcnt lgkmcnt(6)
    v_mfma_f32_32x32x16_bf16 v[152:167], v[192:195], v[76:79], v[152:167]
    ds_read_b64_tr_b16 v[208:209], v221 offset:6144
    ds_read_b64_tr_b16 v[210:211], v221 offset:6656
    s_waitcnt lgkmcnt(6)
    v_mfma_f32_32x32x16_bf16 v[168:183], v[196:199], v[76:79], v[168:183]
    ds_read_b64_tr_b16 v[212:213], v222 offset:6144
    ds_read_b64_tr_b16 v[214:215], v222 offset:6656
    s_waitcnt lgkmcnt(6)
    v_mfma_f32_32x32x16_bf16 v[152:167], v[200:203], v[80:83], v[152:167]
    ds_read_b64_tr_b16 v[184:185], v221 offset:8192
    ds_read_b64_tr_b16 v[186:187], v221 offset:8704
    s_waitcnt lgkmcnt(6)
    v_mfma_f32_32x32x16_bf16 v[168:183], v[204:207], v[80:83], v[168:183]
    ds_read_b64_tr_b16 v[188:189], v222 offset:8192
    ds_read_b64_tr_b16 v[190:191], v222 offset:8704
    s_waitcnt lgkmcnt(6)
    v_mfma_f32_32x32x16_bf16 v[152:167], v[208:211], v[84:87], v[152:167]
    ds_read_b64_tr_b16 v[192:193], v221 offset:10240
    ds_read_b64_tr_b16 v[194:195], v221 offset:10752
    s_waitcnt lgkmcnt(6)
    v_mfma_f32_32x32x16_bf16 v[168:183], v[212:215], v[84:87], v[168:183]
    ds_read_b64_tr_b16 v[196:197], v222 offset:10240
    ds_read_b64_tr_b16 v[198:199], v222 offset:10752
    s_waitcnt lgkmcnt(6)
    v_mfma_f32_32x32x16_bf16 v[152:167], v[184:187], v[88:91], v[152:167]
    ds_read_b64_tr_b16 v[200:201], v221 offset:12288
    ds_read_b64_tr_b16 v[202:203], v221 offset:12800
    s_waitcnt lgkmcnt(6)
    v_mfma_f32_32x32x16_bf16 v[168:183], v[188:191], v[88:91], v[168:183]
    ds_read_b64_tr_b16 v[204:205], v222 offset:12288
    ds_read_b64_tr_b16 v[206:207], v222 offset:12800
    s_waitcnt lgkmcnt(6)
    v_mfma_f32_32x32x16_bf16 v[152:167], v[192:195], v[92:95], v[152:167]
    ds_read_b64_tr_b16 v[208:209], v221 offset:14336
    ds_read_b64_tr_b16 v[210:211], v221 offset:14848
    s_waitcnt lgkmcnt(6)
    v_mfma_f32_32x32x16_bf16 v[168:183], v[196:199], v[92:95], v[168:183]
    ds_read_b64_tr_b16 v[212:213], v222 offset:14336
    ds_read_b64_tr_b16 v[214:215], v222 offset:14848
    s_waitcnt lgkmcnt(6)
    v_mfma_f32_32x32x16_bf16 v[152:167], v[200:203], v[96:99], v[152:167]
    ds_read_b64_tr_b16 v[184:185], v221 offset:16384
    ds_read_b64_tr_b16 v[186:187], v221 offset:16896
    s_waitcnt lgkmcnt(6)
    v_mfma_f32_32x32x16_bf16 v[168:183], v[204:207], v[96:99], v[168:183]
    ds_read_b64_tr_b16 v[188:189], v222 offset:16384
    ds_read_b64_tr_b16 v[190:191], v222 offset:16896
    s_waitcnt lgkmcnt(6)
    v_mfma_f32_32x32x16_bf16 v[152:167], v[208:211], v[100:103], v[152:167]
    ds_read_b64_tr_b16 v[192:193], v221 offset:18432
    ds_read_b64_tr_b16 v[194:195], v221 offset:18944
    s_waitcnt lgkmcnt(6)
    v_mfma_f32_32x32x16_bf16 v[168:183], v[212:215], v[100:103], v[168:183]
    ds_read_b64_tr_b16 v[196:197], v222 offset:18432
    ds_read_b64_tr_b16 v[198:199], v222 offset:18944
    s_waitcnt lgkmcnt(6)
    v_mfma_f32_32x32x16_bf16 v[152:167], v[184:187], v[104:107], v[152:167]
    ds_read_b64_tr_b16 v[200:201], v221 offset:20480
    ds_read_b64_tr_b16 v[202:203], v221 offset:20992
    s_waitcnt lgkmcnt(6)
    v_mfma_f32_32x32x16_bf16 v[168:183], v[188:191], v[104:107], v[168:183]
    ds_read_b64_tr_b16 v[204:205], v222 offset:20480
    ds_read_b64_tr_b16 v[206:207], v222 offset:20992
    s_waitcnt lgkmcnt(6)
    v_mfma_f32_32x32x16_bf16 v[152:167], v[192:195], v[108:111], v[152:167]
    ds_read_b64_tr_b16 v[208:209], v221 offset:22528
    ds_read_b64_tr_b16 v[210:211], v221 offset:23040
    s_waitcnt lgkmcnt(6)
    v_mfma_f32_32x32x16_bf16 v[168:183], v[196:199], v[108:111], v[168:183]
    ds_read_b64_tr_b16 v[212:213], v222 offset:22528
    ds_read_b64_tr_b16 v[214:215], v222 offset:23040
    s_waitcnt lgkmcnt(6)
    v_mfma_f32_32x32x16_bf16 v[152:167], v[200:203], v[112:115], v[152:167]
    s_waitcnt lgkmcnt(4)
    v_mfma_f32_32x32x16_bf16 v[168:183], v[204:207], v[112:115], v[168:183]
    s_waitcnt lgkmcnt(2)
    v_mfma_f32_32x32x16_bf16 v[152:167], v[208:211], v[116:119], v[152:167]
    s_waitcnt lgkmcnt(0)
    v_mfma_f32_32x32x16_bf16 v[168:183], v[212:215], v[116:119], v[168:183]
    s_barrier
    ds_read_b128 v[136:139], v241 offset:0
    ds_read_b128 v[140:143], v241 offset:1024
    s_waitcnt lgkmcnt(0)
    v_mfma_f32_32x32x16_bf16 v[152:167], v[136:139], v[236:239], v[152:167]
    v_mfma_f32_32x32x16_bf16 v[168:183], v[140:143], v[236:239], v[168:183]
    ds_read_b64_tr_b16 v[184:185], v221 offset:57344
    ds_read_b64_tr_b16 v[186:187], v221 offset:57856
    ds_read_b64_tr_b16 v[188:189], v222 offset:57344
    ds_read_b64_tr_b16 v[190:191], v222 offset:57856
    ds_read_b64_tr_b16 v[192:193], v221 offset:59392
    ds_read_b64_tr_b16 v[194:195], v221 offset:59904
    ds_read_b64_tr_b16 v[196:197], v222 offset:59392
    ds_read_b64_tr_b16 v[198:199], v222 offset:59904
    v_mov_b32 v5, 1
    s_mov_b64 exec, 1
    s_waitcnt vmcnt(0)
    ds_add_rtn_u32 v5, v227, v5
    s_mov_b64 exec, -1
    s_waitcnt lgkmcnt(0)
    v_readfirstlane_b32 s60, v5
    s_nop 0
    s_cmp_lg_u32 s60, 3
    s_cbranch_scc1 L_sq_25
    buffer_store_dword v6, v226, s[36:39], 0 offen sc1
L_sq_25:
    v_pk_mul_f32 v[120:121], v[152:153], v[232:233] op_sel_hi:[1,0]
    v_pk_mul_f32 v[122:123], v[154:155], v[232:233] op_sel_hi:[1,0]
    v_pk_mul_f32 v[124:125], v[156:157], v[232:233] op_sel_hi:[1,0]
    v_pk_mul_f32 v[126:127], v[158:159], v[232:233] op_sel_hi:[1,0]
    v_exp_f32 v120, v120
    v_exp_f32 v121, v121
    v_exp_f32 v122, v122
    v_exp_f32 v123, v123
    v_exp_f32 v124, v124
    v_exp_f32 v125, v125
    v_exp_f32 v126, v126
    v_exp_f32 v127, v127
    v_pk_fma_f32 v[120:121], v[120:121], v[230:231], v[230:231] op_sel_hi:[1,0,0]
    v_pk_fma_f32 v[122:123], v[122:123], v[230:231], v[230:231] op_sel_hi:[1,0,0]
    v_pk_fma_f32 v[124:125], v[124:125], v[230:231], v[230:231] op_sel_hi:[1,0,0]
    v_pk_fma_f32 v[126:127], v[126:127], v[230:231], v[230:231] op_sel_hi:[1,0,0]
    v_rcp_f32 v120, v120
    v_rcp_f32 v121, v121
    v_rcp_f32 v122, v122
    v_rcp_f32 v123, v123
    v_rcp_f32 v124, v124
    v_rcp_f32 v125, v125
    v_rcp_f32 v126, v126
    v_rcp_f32 v127, v127
    v_pk_mul_f32 v[120:121], v[120:121], v[152:153]
    v_pk_mul_f32 v[122:123], v[122:123], v[154:155]
    v_pk_mul_f32 v[124:125], v[124:125], v[156:157]
    v_pk_mul_f32 v[126:127], v[126:127], v[158:159]
    v_cvt_pk_bf16_f32 v136, v120, v121
    v_cvt_pk_bf16_f32 v137, v122, v123
    v_cvt_pk_bf16_f32 v138, v124, v125
    v_cvt_pk_bf16_f32 v139, v126, v127
    buffer_store_dwordx4 v[136:139], v223, s[36:39], s62 offen offset:0 sc1
    v_pk_mul_f32 v[128:129], v[160:161], v[232:233] op_sel_hi:[1,0]
    v_pk_mul_f32 v[130:131], v[162:163], v[232:233] op_sel_hi:[1,0]
    v_pk_mul_f32 v[132:133], v[164:165], v[232:233] op_sel_hi:[1,0]
    v_pk_mul_f32 v[134:135], v[166:167], v[232:233] op_sel_hi:[1,0]
    v_exp_f32 v128, v128
    v_exp_f32 v129, v129
    v_exp_f32 v130, v130
    v_exp_f32 v131, v131
    v_exp_f32 v132, v132
    v_exp_f32 v133, v133
    v_exp_f32 v134, v134
    v_exp_f32 v135, v135
    v_pk_fma_f32 v[128:129], v[128:129], v[230:231], v[230:231] op_sel_hi:[1,0,0]
    v_pk_fma_f32 v[130:131], v[130:131], v[230:231], v[230:231] op_sel_hi:[1,0,0]
    v_pk_fma_f32 v[132:133], v[132:133], v[230:231], v[230:231] op_sel_hi:[1,0,0]
    v_pk_fma_f32 v[134:135], v[134:135], v[230:231], v[230:231] op_sel_hi:[1,0,0]
    v_rcp_f32 v128, v128
    v_rcp_f32 v129, v129
    v_rcp_f32 v130, v130
    v_rcp_f32 v131, v131
    v_rcp_f32 v132, v132
    v_rcp_f32 v133, v133
    v_rcp_f32 v134, v134
    v_rcp_f32 v135, v135
    v_pk_mul_f32 v[128:129], v[128:129], v[160:161]
    v_pk_mul_f32 v[130:131], v[130:131], v[162:163]
    v_pk_mul_f32 v[132:133], v[132:133], v[164:165]
    v_pk_mul_f32 v[134:135], v[134:135], v[166:167]
    v_cvt_pk_bf16_f32 v140, v128, v129
    v_cvt_pk_bf16_f32 v141, v130, v131
    v_cvt_pk_bf16_f32 v142, v132, v133
    v_cvt_pk_bf16_f32 v143, v134, v135
    buffer_store_dwordx4 v[140:143], v223, s[36:39], s62 offen offset:1024 sc1
    v_pk_mul_f32 v[120:121], v[168:169], v[232:233] op_sel_hi:[1,0]
    v_pk_mul_f32 v[122:123], v[170:171], v[232:233] op_sel_hi:[1,0]
    v_pk_mul_f32 v[124:125], v[172:173], v[232:233] op_sel_hi:[1,0]
    v_pk_mul_f32 v[126:127], v[174:175], v[232:233] op_sel_hi:[1,0]
    v_exp_f32 v120, v120
    v_exp_f32 v121, v121
    v_exp_f32 v122, v122
    v_exp_f32 v123, v123
    v_exp_f32 v124, v124
    v_exp_f32 v125, v125
    v_exp_f32 v126, v126
    v_exp_f32 v127, v127
    v_pk_fma_f32 v[120:121], v[120:121], v[230:231], v[230:231] op_sel_hi:[1,0,0]
    v_pk_fma_f32 v[122:123], v[122:123], v[230:231], v[230:231] op_sel_hi:[1,0,0]
    v_pk_fma_f32 v[124:125], v[124:125], v[230:231], v[230:231] op_sel_hi:[1,0,0]
    v_pk_fma_f32 v[126:127], v[126:127], v[230:231], v[230:231] op_sel_hi:[1,0,0]
    v_rcp_f32 v120, v120
    v_rcp_f32 v121, v121
    v_rcp_f32 v122, v122
    v_rcp_f32 v123, v123
    v_rcp_f32 v124, v124
    v_rcp_f32 v125, v125
    v_rcp_f32 v126, v126
    v_rcp_f32 v127, v127
    v_pk_mul_f32 v[120:121], v[120:121], v[168:169]
    v_pk_mul_f32 v[122:123], v[122:123], v[170:171]
    v_pk_mul_f32 v[124:125], v[124:125], v[172:173]
    v_pk_mul_f32 v[126:127], v[126:127], v[174:175]
    v_cvt_pk_bf16_f32 v144, v120, v121
    v_cvt_pk_bf16_f32 v145, v122, v123
    v_cvt_pk_bf16_f32 v146, v124, v125
    v_cvt_pk_bf16_f32 v147, v126, v127
    buffer_store_dwordx4 v[144:147], v223, s[36:39], s62 offen offset:2048 sc1
    v_pk_mul_f32 v[128:129], v[176:177], v[232:233] op_sel_hi:[1,0]
    v_pk_mul_f32 v[130:131], v[178:179], v[232:233] op_sel_hi:[1,0]
    v_pk_mul_f32 v[132:133], v[180:181], v[232:233] op_sel_hi:[1,0]
    v_pk_mul_f32 v[134:135], v[182:183], v[232:233] op_sel_hi:[1,0]
    v_exp_f32 v128, v128
    v_exp_f32 v129, v129
    v_exp_f32 v130, v130
    v_exp_f32 v131, v131
    v_exp_f32 v132, v132
    v_exp_f32 v133, v133
    v_exp_f32 v134, v134
    v_exp_f32 v135, v135
    v_pk_fma_f32 v[128:129], v[128:129], v[230:231], v[230:231] op_sel_hi:[1,0,0]
    v_pk_fma_f32 v[130:131], v[130:131], v[230:231], v[230:231] op_sel_hi:[1,0,0]
    v_pk_fma_f32 v[132:133], v[132:133], v[230:231], v[230:231] op_sel_hi:[1,0,0]
    v_pk_fma_f32 v[134:135], v[134:135], v[230:231], v[230:231] op_sel_hi:[1,0,0]
    v_rcp_f32 v128, v128
    v_rcp_f32 v129, v129
    v_rcp_f32 v130, v130
    v_rcp_f32 v131, v131
    v_rcp_f32 v132, v132
    v_rcp_f32 v133, v133
    v_rcp_f32 v134, v134
    v_rcp_f32 v135, v135
    v_pk_mul_f32 v[128:129], v[128:129], v[176:177]
    v_pk_mul_f32 v[130:131], v[130:131], v[178:179]
    v_pk_mul_f32 v[132:133], v[132:133], v[180:181]
    v_pk_mul_f32 v[134:135], v[134:135], v[182:183]
    v_cvt_pk_bf16_f32 v148, v128, v129
    v_cvt_pk_bf16_f32 v149, v130, v131
    v_cvt_pk_bf16_f32 v150, v132, v133
    v_cvt_pk_bf16_f32 v151, v134, v135
    buffer_store_dwordx4 v[148:151], v223, s[36:39], s62 offen offset:3072 sc1
    v_mfma_f32_32x32x16_bf16 v[152:167], v[184:187], v[8:11], 0
    ds_read_b64_tr_b16 v[200:201], v221 offset:61440
    ds_read_b64_tr_b16 v[202:203], v221 offset:61952
    v_mfma_f32_32x32x16_bf16 v[168:183], v[188:191], v[8:11], 0
    ds_read_b64_tr_b16 v[204:205], v222 offset:61440
    ds_read_b64_tr_b16 v[206:207], v222 offset:61952
    v_mfma_f32_32x32x16_bf16 v[152:167], v[192:195], v[12:15], v[152:167]
    ds_read_b64_tr_b16 v[208:209], v221 offset:63488
    ds_read_b64_tr_b16 v[210:211], v221 offset:64000
    v_mfma_f32_32x32x16_bf16 v[168:183], v[196:199], v[12:15], v[168:183]
    ds_read_b64_tr_b16 v[212:213], v222 offset:63488
    ds_read_b64_tr_b16 v[214:215], v222 offset:64000
    s_waitcnt lgkmcnt(6)
    v_mfma_f32_32x32x16_bf16 v[152:167], v[200:203], v[16:19], v[152:167]
    ds_read_b64_tr_b16 v[184:185], v224 offset:0
    ds_read_b64_tr_b16 v[186:187], v224 offset:512
    s_waitcnt lgkmcnt(6)
    v_mfma_f32_32x32x16_bf16 v[168:183], v[204:207], v[16:19], v[168:183]
    ds_read_b64_tr_b16 v[188:189], v225 offset:0
    ds_read_b64_tr_b16 v[190:191], v225 offset:512
    s_waitcnt lgkmcnt(6)
    v_mfma_f32_32x32x16_bf16 v[152:167], v[208:211], v[20:23], v[152:167]
    ds_read_b64_tr_b16 v[192:193], v224 offset:2048
    ds_read_b64_tr_b16 v[194:195], v224 offset:2560
    s_waitcnt lgkmcnt(6)
    v_mfma_f32_32x32x16_bf16 v[168:183], v[212:215], v[20:23], v[168:183]
    ds_read_b64_tr_b16 v[196:197], v225 offset:2048
    ds_read_b64_tr_b16 v[198:199], v225 offset:2560
    s_waitcnt lgkmcnt(6)
    v_mfma_f32_32x32x16_bf16 v[152:167], v[184:187], v[24:27], v[152:167]
    ds_read_b64_tr_b16 v[200:201], v224 offset:4096
    ds_read_b64_tr_b16 v[202:203], v224 offset:4608
    s_waitcnt lgkmcnt(6)
    v_mfma_f32_32x32x16_bf16 v[168:183], v[188:191], v[24:27], v[168:183]
    ds_read_b64_tr_b16 v[204:205], v225 offset:4096
    ds_read_b64_tr_b16 v[206:207], v225 offset:4608
    s_waitcnt lgkmcnt(6)
    v_mfma_f32_32x32x16_bf16 v[152:167], v[192:195], v[28:31], v[152:167]
    ds_read_b64_tr_b16 v[208:209], v224 offset:6144
    ds_read_b64_tr_b16 v[210:211], v224 offset:6656
    s_waitcnt lgkmcnt(6)
    v_mfma_f32_32x32x16_bf16 v[168:183], v[196:199], v[28:31], v[168:183]
    ds_read_b64_tr_b16 v[212:213], v225 offset:6144
    ds_read_b64_tr_b16 v[214:215], v225 offset:6656
    s_waitcnt lgkmcnt(6)
    v_mfma_f32_32x32x16_bf16 v[152:167], v[200:203], v[32:35], v[152:167]
    ds_read_b64_tr_b16 v[184:185], v224 offset:8192
    ds_read_b64_tr_b16 v[186:187], v224 offset:8704
    s_waitcnt lgkmcnt(6)
    v_mfma_f32_32x32x16_bf16 v[168:183], v[204:207], v[32:35], v[168:183]
    ds_read_b64_tr_b16 v[188:189], v225 offset:8192
    ds_read_b64_tr_b16 v[190:191], v225 offset:8704
    s_waitcnt lgkmcnt(6)
    v_mfma_f32_32x32x16_bf16 v[152:167], v[208:211], v[36:39], v[152:167]
    ds_read_b64_tr_b16 v[192:193], v224 offset:10240
    ds_read_b64_tr_b16 v[194:195], v224 offset:10752
    s_waitcnt lgkmcnt(6)
    v_mfma_f32_32x32x16_bf16 v[168:183], v[212:215], v[36:39], v[168:183]
    ds_read_b64_tr_b16 v[196:197], v225 offset:10240
    ds_read_b64_tr_b16 v[198:199], v225 offset:10752
    s_waitcnt lgkmcnt(6)
    v_mfma_f32_32x32x16_bf16 v[152:167], v[184:187], v[40:43], v[152:167]
    ds_read_b64_tr_b16 v[200:201], v224 offset:12288
    ds_read_b64_tr_b16 v[202:203], v224 offset:12800
    s_waitcnt lgkmcnt(6)
    v_mfma_f32_32x32x16_bf16 v[168:183], v[188:191], v[40:43], v[168:183]
    ds_read_b64_tr_b16 v[204:205], v225 offset:12288
    ds_read_b64_tr_b16 v[206:207], v225 offset:12800
    s_waitcnt lgkmcnt(6)
    v_mfma_f32_32x32x16_bf16 v[152:167], v[192:195], v[44:47], v[152:167]
    ds_read_b64_tr_b16 v[208:209], v224 offset:14336
    ds_read_b64_tr_b16 v[210:211], v224 offset:14848
    s_waitcnt lgkmcnt(6)
    v_mfma_f32_32x32x16_bf16 v[168:183], v[196:199], v[44:47], v[168:183]
    ds_read_b64_tr_b16 v[212:213], v225 offset:14336
    ds_read_b64_tr_b16 v[214:215], v225 offset:14848
    s_waitcnt lgkmcnt(6)
    v_mfma_f32_32x32x16_bf16 v[152:167], v[200:203], v[48:51], v[152:167]
    ds_read_b64_tr_b16 v[184:185], v224 offset:16384
    ds_read_b64_tr_b16 v[186:187], v224 offset:16896
    s_waitcnt lgkmcnt(6)
    v_mfma_f32_32x32x16_bf16 v[168:183], v[204:207], v[48:51], v[168:183]
    ds_read_b64_tr_b16 v[188:189], v225 offset:16384
    ds_read_b64_tr_b16 v[190:191], v225 offset:16896
    s_waitcnt lgkmcnt(6)
    v_mfma_f32_32x32x16_bf16 v[152:167], v[208:211], v[52:55], v[152:167]
    ds_read_b64_tr_b16 v[192:193], v224 offset:18432
    ds_read_b64_tr_b16 v[194:195], v224 offset:18944
    s_waitcnt lgkmcnt(6)
    v_mfma_f32_32x32x16_bf16 v[168:183], v[212:215], v[52:55], v[168:183]
    ds_read_b64_tr_b16 v[196:197], v225 offset:18432
    ds_read_b64_tr_b16 v[198:199], v225 offset:18944
    s_waitcnt lgkmcnt(6)
    v_mfma_f32_32x32x16_bf16 v[152:167], v[184:187], v[56:59], v[152:167]
    ds_read_b64_tr_b16 v[200:201], v224 offset:20480
    ds_read_b64_tr_b16 v[202:203], v224 offset:20992
    s_waitcnt lgkmcnt(6)
    v_mfma_f32_32x32x16_bf16 v[168:183], v[188:191], v[56:59], v[168:183]
    ds_read_b64_tr_b16 v[204:205], v225 offset:20480
    ds_read_b64_tr_b16 v[206:207], v225 offset:20992
    s_waitcnt lgkmcnt(6)
    v_mfma_f32_32x32x16_bf16 v[152:167], v[192:195], v[60:63], v[152:167]
    ds_read_b64_tr_b16 v[208:209], v224 offset:22528
    ds_read_b64_tr_b16 v[210:211], v224 offset:23040
    s_waitcnt lgkmcnt(6)
    v_mfma_f32_32x32x16_bf16 v[168:183], v[196:199], v[60:63], v[168:183]
    ds_read_b64_tr_b16 v[212:213], v225 offset:22528
    ds_read_b64_tr_b16 v[214:215], v225 offset:23040
    v_mov_b32 v4, 161812
    v_mov_b32 v5, 1
    s_mov_b64 exec, 1
    s_waitcnt vmcnt(0)
    ds_add_rtn_u32 v5, v4, v5
    s_mov_b64 exec, -1
    s_waitcnt lgkmcnt(7)
    v_mfma_f32_32x32x16_bf16 v[152:167], v[200:203], v[64:67], v[152:167]
    ds_read_b64_tr_b16 v[184:185], v224 offset:24576
    ds_read_b64_tr_b16 v[186:187], v224 offset:25088
    s_waitcnt lgkmcnt(7)
    v_mfma_f32_32x32x16_bf16 v[168:183], v[204:207], v[64:67], v[168:183]
    ds_read_b64_tr_b16 v[188:189], v225 offset:24576
    ds_read_b64_tr_b16 v[190:191], v225 offset:25088
    s_waitcnt lgkmcnt(7)
    v_mfma_f32_32x32x16_bf16 v[152:167], v[208:211], v[68:71], v[152:167]
    ds_read_b64_tr_b16 v[192:193], v224 offset:26624
    ds_read_b64_tr_b16 v[194:195], v224 offset:27136
    s_waitcnt lgkmcnt(7)
    v_mfma_f32_32x32x16_bf16 v[168:183], v[212:215], v[68:71], v[168:183]
    ds_read_b64_tr_b16 v[196:197], v225 offset:26624
    ds_read_b64_tr_b16 v[198:199], v225 offset:27136
    s_waitcnt lgkmcnt(8)
    v_readfirstlane_b32 s60, v5
    s_nop 0
    s_cmp_lg_u32 s60, 3
    s_cbranch_scc1 L_ws_26
    s_add_u32 s60, s7, 0
    s_bfm_b64 exec, 14, 0
    buffer_store_dword v6, v7, s[36:39], s60 offen sc1
    s_mov_b64 exec, -1
L_ws_26:
    s_waitcnt lgkmcnt(6)
    v_mfma_f32_32x32x16_bf16 v[152:167], v[184:187], v[72:75], v[152:167]
    ds_read_b64_tr_b16 v[200:201], v224 offset:28672
    ds_read_b64_tr_b16 v[202:203], v224 offset:29184
    s_waitcnt lgkmcnt(6)
    v_mfma_f32_32x32x16_bf16 v[168:183], v[188:191], v[72:75], v[168:183]
    ds_read_b64_tr_b16 v[204:205], v225 offset:28672
    ds_read_b64_tr_b16 v[206:207], v225 offset:29184
    s_waitcnt lgkmcnt(6)
    v_mfma_f32_32x32x16_bf16 v[152:167], v[192:195], v[76:79], v[152:167]
    ds_read_b64_tr_b16 v[208:209], v224 offset:30720
    ds_read_b64_tr_b16 v[210:211], v224 offset:31232
    s_waitcnt lgkmcnt(6)
    v_mfma_f32_32x32x16_bf16 v[168:183], v[196:199], v[76:79], v[168:183]
    ds_read_b64_tr_b16 v[212:213], v225 offset:30720
    ds_read_b64_tr_b16 v[214:215], v225 offset:31232
    s_waitcnt lgkmcnt(6)
    v_mfma_f32_32x32x16_bf16 v[152:167], v[200:203], v[80:83], v[152:167]
    ds_read_b64_tr_b16 v[184:185], v224 offset:32768
    ds_read_b64_tr_b16 v[186:187], v224 offset:33280
    s_waitcnt lgkmcnt(6)
    v_mfma_f32_32x32x16_bf16 v[168:183], v[204:207], v[80:83], v[168:183]
    ds_read_b64_tr_b16 v[188:189], v225 offset:32768
    ds_read_b64_tr_b16 v[190:191], v225 offset:33280
    s_waitcnt lgkmcnt(6)
    v_mfma_f32_32x32x16_bf16 v[152:167], v[208:211], v[84:87], v[152:167]
    ds_read_b64_tr_b16 v[192:193], v224 offset:34816
    ds_read_b64_tr_b16 v[194:195], v224 offset:35328
    s_waitcnt lgkmcnt(6)
    v_mfma_f32_32x32x16_bf16 v[168:183], v[212:215], v[84:87], v[168:183]
    ds_read_b64_tr_b16 v[196:197], v225 offset:34816
    ds_read_b64_tr_b16 v[198:199], v225 offset:35328
    s_waitcnt lgkmcnt(6)
    v_mfma_f32_32x32x16_bf16 v[152:167], v[184:187], v[88:91], v[152:167]
    ds_read_b64_tr_b16 v[200:201], v224 offset:36864
    ds_read_b64_tr_b16 v[202:203], v224 offset:37376
    s_waitcnt lgkmcnt(6)
    v_mfma_f32_32x32x16_bf16 v[168:183], v[188:191], v[88:91], v[168:183]
    ds_read_b64_tr_b16 v[204:205], v225 offset:36864
    ds_read_b64_tr_b16 v[206:207], v225 offset:37376
    s_waitcnt lgkmcnt(6)
    v_mfma_f32_32x32x16_bf16 v[152:167], v[192:195], v[92:95], v[152:167]
    ds_read_b64_tr_b16 v[208:209], v224 offset:38912
    ds_read_b64_tr_b16 v[210:211], v224 offset:39424
    s_waitcnt lgkmcnt(6)
    v_mfma_f32_32x32x16_bf16 v[168:183], v[196:199], v[92:95], v[168:183]
    ds_read_b64_tr_b16 v[212:213], v225 offset:38912
    ds_read_b64_tr_b16 v[214:215], v225 offset:39424
    s_waitcnt lgkmcnt(6)
    v_mfma_f32_32x32x16_bf16 v[152:167], v[200:203], v[96:99], v[152:167]
    ds_read_b64_tr_b16 v[184:185], v224 offset:40960
    ds_read_b64_tr_b16 v[186:187], v224 offset:41472
    s_waitcnt lgkmcnt(6)
    v_mfma_f32_32x32x16_bf16 v[168:183], v[204:207], v[96:99], v[168:183]
    ds_read_b64_tr_b16 v[188:189], v225 offset:40960
    ds_read_b64_tr_b16 v[190:191], v225 offset:41472
    s_waitcnt lgkmcnt(6)
    v_mfma_f32_32x32x16_bf16 v[152:167], v[208:211], v[100:103], v[152:167]
    ds_read_b64_tr_b16 v[192:193], v224 offset:43008
    ds_read_b64_tr_b16 v[194:195], v224 offset:43520
    s_waitcnt lgkmcnt(6)
    v_mfma_f32_32x32x16_bf16 v[168:183], v[212:215], v[100:103], v[168:183]
    ds_read_b64_tr_b16 v[196:197], v225 offset:43008
    ds_read_b64_tr_b16 v[198:199], v225 offset:43520
    s_waitcnt lgkmcnt(6)
    v_mfma_f32_32x32x16_bf16 v[152:167], v[184:187], v[104:107], v[152:167]
    ds_read_b64_tr_b16 v[200:201], v224 offset:45056
    ds_read_b64_tr_b16 v[202:203], v224 offset:45568
    s_waitcnt lgkmcnt(6)
    v_mfma_f32_32x32x16_bf16 v[168:183], v[188:191], v[104:107], v[168:183]
    ds_read_b64_tr_b16 v[204:205], v225 offset:45056
    ds_read_b64_tr_b16 v[206:207], v225 offset:45568
    s_waitcnt lgkmcnt(6)
    v_mfma_f32_32x32x16_bf16 v[152:167], v[192:195], v[108:111], v[152:167]
    ds_read_b64_tr_b16 v[208:209], v224 offset:47104
    ds_read_b64_tr_b16 v[210:211], v224 offset:47616
    s_waitcnt lgkmcnt(6)
    v_mfma_f32_32x32x16_bf16 v[168:183], v[196:199], v[108:111], v[168:183]
    ds_read_b64_tr_b16 v[212:213], v225 offset:47104
    ds_read_b64_tr_b16 v[214:215], v225 offset:47616
    s_waitcnt lgkmcnt(6)
    v_mfma_f32_32x32x16_bf16 v[152:167], v[200:203], v[112:115], v[152:167]
    s_waitcnt lgkmcnt(4)
    v_mfma_f32_32x32x16_bf16 v[168:183], v[204:207], v[112:115], v[168:183]
    v_mov_b32 v4, 161796
    ds_read_b32 v5, v4
    s_waitcnt lgkmcnt(3)
    v_mfma_f32_32x32x16_bf16 v[152:167], v[208:211], v[116:119], v[152:167]
    s_waitcnt lgkmcnt(1)
    v_mfma_f32_32x32x16_bf16 v[168:183], v[212:215], v[116:119], v[168:183]
L_cs1_27:
    s_waitcnt lgkmcnt(0)
    v_readfirstlane_b32 s60, v5
    s_nop 0
    s_cmp_ge_u32 s60, 4
    s_cbranch_scc1 L_cs1_27ok
    ds_read_b32 v5, v4
    s_branch L_cs1_27
L_cs1_27ok:
    ds_read_b128 v[24:27], v241 offset:2048
    ds_read_b128 v[28:31], v241 offset:3072
    s_waitcnt lgkmcnt(0)
    v_mfma_f32_32x32x16_bf16 v[152:167], v[24:27], v[236:239], v[152:167]
    v_mfma_f32_32x32x16_bf16 v[168:183], v[28:31], v[236:239], v[168:183]
    v_mov_b32 v5, 1
    s_mov_b64 exec, 1
    ds_add_u32 v4, v5
    s_mov_b64 exec, -1
    s_nop 6
    v_pk_mul_f32 v[8:9], v[152:153], v[232:233] op_sel_hi:[1,0]
    v_pk_mul_f32 v[10:11], v[154:155], v[232:233] op_sel_hi:[1,0]
    v_pk_mul_f32 v[12:13], v[156:157], v[232:233] op_sel_hi:[1,0]
    v_pk_mul_f32 v[14:15], v[158:159], v[232:233] op_sel_hi:[1,0]
    v_exp_f32 v8, v8
    v_exp_f32 v9, v9
    v_exp_f32 v10, v10
    v_exp_f32 v11, v11
    v_exp_f32 v12, v12
    v_exp_f32 v13, v13
    v_exp_f32 v14, v14
    v_exp_f32 v15, v15
    v_pk_fma_f32 v[8:9], v[8:9], v[230:231], v[230:231] op_sel_hi:[1,0,0]
    v_pk_fma_f32 v[10:11], v[10:11], v[230:231], v[230:231] op_sel_hi:[1,0,0]
    v_pk_fma_f32 v[12:13], v[12:13], v[230:231], v[230:231] op_sel_hi:[1,0,0]
    v_pk_fma_f32 v[14:15], v[14:15], v[230:231], v[230:231] op_sel_hi:[1,0,0]
    v_rcp_f32 v8, v8
    v_rcp_f32 v9, v9
    v_rcp_f32 v10, v10
    v_rcp_f32 v11, v11
    v_rcp_f32 v12, v12
    v_rcp_f32 v13, v13
    v_rcp_f32 v14, v14
    v_rcp_f32 v15, v15
    v_pk_mul_f32 v[8:9], v[8:9], v[152:153]
    v_pk_mul_f32 v[10:11], v[10:11], v[154:155]
    v_pk_mul_f32 v[12:13], v[12:13], v[156:157]
    v_pk_mul_f32 v[14:15], v[14:15], v[158:159]
    v_cvt_pk_bf16_f32 v32, v8, v9
    v_cvt_pk_bf16_f32 v33, v10, v11
    v_cvt_pk_bf16_f32 v34, v12, v13
    v_cvt_pk_bf16_f32 v35, v14, v15
    buffer_store_dwordx4 v[32:35], v223, s[36:39], s63 offen offset:0 sc1
    v_pk_mul_f32 v[16:17], v[160:161], v[232:233] op_sel_hi:[1,0]
    v_pk_mul_f32 v[18:19], v[162:163], v[232:233] op_sel_hi:[1,0]
    v_pk_mul_f32 v[20:21], v[164:165], v[232:233] op_sel_hi:[1,0]
    v_pk_mul_f32 v[22:23], v[166:167], v[232:233] op_sel_hi:[1,0]
    v_exp_f32 v16, v16
    v_exp_f32 v17, v17
    v_exp_f32 v18, v18
    v_exp_f32 v19, v19
    v_exp_f32 v20, v20
    v_exp_f32 v21, v21
    v_exp_f32 v22, v22
    v_exp_f32 v23, v23
    v_pk_fma_f32 v[16:17], v[16:17], v[230:231], v[230:231] op_sel_hi:[1,0,0]
    v_pk_fma_f32 v[18:19], v[18:19], v[230:231], v[230:231] op_sel_hi:[1,0,0]
    v_pk_fma_f32 v[20:21], v[20:21], v[230:231], v[230:231] op_sel_hi:[1,0,0]
    v_pk_fma_f32 v[22:23], v[22:23], v[230:231], v[230:231] op_sel_hi:[1,0,0]
    v_rcp_f32 v16, v16
    v_rcp_f32 v17, v17
    v_rcp_f32 v18, v18
    v_rcp_f32 v19, v19
    v_rcp_f32 v20, v20
    v_rcp_f32 v21, v21
    v_rcp_f32 v22, v22
    v_rcp_f32 v23, v23
    v_pk_mul_f32 v[16:17], v[16:17], v[160:161]
    v_pk_mul_f32 v[18:19], v[18:19], v[162:163]
    v_pk_mul_f32 v[20:21], v[20:21], v[164:165]
    v_pk_mul_f32 v[22:23], v[22:23], v[166:167]
    v_cvt_pk_bf16_f32 v36, v16, v17
    v_cvt_pk_bf16_f32 v37, v18, v19
    v_cvt_pk_bf16_f32 v38, v20, v21
    v_cvt_pk_bf16_f32 v39, v22, v23
    buffer_store_dwordx4 v[36:39], v223, s[36:39], s63 offen offset:1024 sc1
    v_pk_mul_f32 v[8:9], v[168:169], v[232:233] op_sel_hi:[1,0]
    v_pk_mul_f32 v[10:11], v[170:171], v[232:233] op_sel_hi:[1,0]
    v_pk_mul_f32 v[12:13], v[172:173], v[232:233] op_sel_hi:[1,0]
    v_pk_mul_f32 v[14:15], v[174:175], v[232:233] op_sel_hi:[1,0]
    v_exp_f32 v8, v8
    v_exp_f32 v9, v9
    v_exp_f32 v10, v10
    v_exp_f32 v11, v11
    v_exp_f32 v12, v12
    v_exp_f32 v13, v13
    v_exp_f32 v14, v14
    v_exp_f32 v15, v15
    v_pk_fma_f32 v[8:9], v[8:9], v[230:231], v[230:231] op_sel_hi:[1,0,0]
    v_pk_fma_f32 v[10:11], v[10:11], v[230:231], v[230:231] op_sel_hi:[1,0,0]
    v_pk_fma_f32 v[12:13], v[12:13], v[230:231], v[230:231] op_sel_hi:[1,0,0]
    v_pk_fma_f32 v[14:15], v[14:15], v[230:231], v[230:231] op_sel_hi:[1,0,0]
    v_rcp_f32 v8, v8
    v_rcp_f32 v9, v9
    v_rcp_f32 v10, v10
    v_rcp_f32 v11, v11
    v_rcp_f32 v12, v12
    v_rcp_f32 v13, v13
    v_rcp_f32 v14, v14
    v_rcp_f32 v15, v15
    v_pk_mul_f32 v[8:9], v[8:9], v[168:169]
    v_pk_mul_f32 v[10:11], v[10:11], v[170:171]
    v_pk_mul_f32 v[12:13], v[12:13], v[172:173]
    v_pk_mul_f32 v[14:15], v[14:15], v[174:175]
    v_cvt_pk_bf16_f32 v40, v8, v9
    v_cvt_pk_bf16_f32 v41, v10, v11
    v_cvt_pk_bf16_f32 v42, v12, v13
    v_cvt_pk_bf16_f32 v43, v14, v15
    buffer_store_dwordx4 v[40:43], v223, s[36:39], s63 offen offset:2048 sc1
    v_pk_mul_f32 v[16:17], v[176:177], v[232:233] op_sel_hi:[1,0]
    v_pk_mul_f32 v[18:19], v[178:179], v[232:233] op_sel_hi:[1,0]
    v_pk_mul_f32 v[20:21], v[180:181], v[232:233] op_sel_hi:[1,0]
    v_pk_mul_f32 v[22:23], v[182:183], v[232:233] op_sel_hi:[1,0]
    v_exp_f32 v16, v16
    v_exp_f32 v17, v17
    v_exp_f32 v18, v18
    v_exp_f32 v19, v19
    v_exp_f32 v20, v20
    v_exp_f32 v21, v21
    v_exp_f32 v22, v22
    v_exp_f32 v23, v23
    v_pk_fma_f32 v[16:17], v[16:17], v[230:231], v[230:231] op_sel_hi:[1,0,0]
    v_pk_fma_f32 v[18:19], v[18:19], v[230:231], v[230:231] op_sel_hi:[1,0,0]
    v_pk_fma_f32 v[20:21], v[20:21], v[230:231], v[230:231] op_sel_hi:[1,0,0]
    v_pk_fma_f32 v[22:23], v[22:23], v[230:231], v[230:231] op_sel_hi:[1,0,0]
    v_rcp_f32 v16, v16
    v_rcp_f32 v17, v17
    v_rcp_f32 v18, v18
    v_rcp_f32 v19, v19
    v_rcp_f32 v20, v20
    v_rcp_f32 v21, v21
    v_rcp_f32 v22, v22
    v_rcp_f32 v23, v23
    v_pk_mul_f32 v[16:17], v[16:17], v[176:177]
    v_pk_mul_f32 v[18:19], v[18:19], v[178:179]
    v_pk_mul_f32 v[20:21], v[20:21], v[180:181]
    v_pk_mul_f32 v[22:23], v[22:23], v[182:183]
    v_cvt_pk_bf16_f32 v44, v16, v17
    v_cvt_pk_bf16_f32 v45, v18, v19
    v_cvt_pk_bf16_f32 v46, v20, v21
    v_cvt_pk_bf16_f32 v47, v22, v23
    buffer_store_dwordx4 v[44:47], v223, s[36:39], s63 offen offset:3072 sc1
L_A_attn:
    v_mov_b32 v4, 161800
L_kvr_28:
    ds_read_b32 v5, v4
    s_waitcnt lgkmcnt(0)
    v_readfirstlane_b32 s60, v5
    s_nop 0
    s_cmp_ge_u32 s60, 4
    s_cbranch_scc1 L_kvr_28ok
    s_sleep 1
    s_branch L_kvr_28
L_kvr_28ok:
    s_setprio 2
    ds_read_b128 v[224:227], v250 offset:49152
    ds_read_b128 v[228:231], v251 offset:49152
    ds_read_b128 v[208:211], v250 offset:0
    ds_read_b128 v[212:215], v251 offset:0
    ds_read_b128 v[216:219], v250 offset:16384
    ds_read_b128 v[220:223], v251 offset:16384
    ds_read_b128 v[232:235], v250 offset:2048
    ds_read_b128 v[236:239], v251 offset:2048
    v_mov_b32 v2, 0xffff
    v_mov_b32 v3, 0xffff0000
    v_cndmask_b32 v56, 0, v2, s[64:65]
    v_cndmask_b32 v4, 0, v3, s[66:67]
    v_or_b32 v56, v56, v4
    v_cndmask_b32 v57, 0, v2, s[68:69]
    v_cndmask_b32 v5, 0, v3, s[70:71]
    v_or_b32 v57, v57, v5
    v_cndmask_b32 v58, 0, v2, s[72:73]
    v_cndmask_b32 v4, 0, v3, s[74:75]
    s_waitcnt lgkmcnt(4)
    v_mfma_f32_32x32x16_bf16 v[64:79], v[208:211], v[224:227], 0
    ds_read_b128 v[240:243], v250 offset:4096
    ds_read_b128 v[244:247], v251 offset:4096
    v_or_b32 v58, v58, v4
    v_cndmask_b32 v59, 0, v2, s[76:77]
    v_cndmask_b32 v5, 0, v3, s[78:79]
    v_or_b32 v59, v59, v5
    v_mfma_f32_32x32x16_bf16 v[64:79], v[212:215], v[228:231], v[64:79]
    v_cndmask_b32 v60, 0, v2, s[80:81]
    v_cndmask_b32 v4, 0, v3, s[82:83]
    v_or_b32 v60, v60, v4
    v_cndmask_b32 v61, 0, v2, s[84:85]
    s_waitcnt lgkmcnt(4)
    v_mfma_f32_32x32x16_bf16 v[192:207], v[216:219], v[224:227], 0
    ds_read_b128 v[208:211], v250 offset:6144
    ds_read_b128 v[212:215], v251 offset:6144
    v_cndmask_b32 v5, 0, v3, s[86:87]
    v_or_b32 v61, v61, v5
    v_cndmask_b32 v62, 0, v2, s[88:89]
    v_cndmask_b32 v4, 0, v3, s[90:91]
    v_mfma_f32_32x32x16_bf16 v[192:207], v[220:223], v[228:231], v[192:207]
    v_or_b32 v62, v62, v4
    v_cndmask_b32 v63, 0, v2, s[92:93]
    v_cndmask_b32 v5, 0, v3, s[94:95]
    v_or_b32 v63, v63, v5
    s_waitcnt lgkmcnt(4)
    v_mfma_f32_32x32x16_bf16 v[80:95], v[232:235], v[224:227], 0
    ds_read_b128 v[216:219], v250 offset:8192
    ds_read_b128 v[220:223], v251 offset:8192
    v_mfma_f32_32x32x16_bf16 v[80:95], v[236:239], v[228:231], v[80:95]
    s_waitcnt lgkmcnt(4)
    v_mfma_f32_32x32x16_bf16 v[96:111], v[240:243], v[224:227], 0
    ds_read_b128 v[232:235], v250 offset:10240
    ds_read_b128 v[236:239], v251 offset:10240
    v_cndmask_b32 v64, v192, v64, s[64:65]
    v_cndmask_b32 v65, v193, v65, s[66:67]
    v_cndmask_b32 v66, v194, v66, s[68:69]
    v_cndmask_b32 v67, v195, v67, s[70:71]
    v_cndmask_b32 v68, v196, v68, s[72:73]
    v_mfma_f32_32x32x16_bf16 v[96:111], v[244:247], v[228:231], v[96:111]
    v_cndmask_b32 v69, v197, v69, s[74:75]
    v_cndmask_b32 v70, v198, v70, s[76:77]
    v_cndmask_b32 v71, v199, v71, s[78:79]
    v_cndmask_b32 v72, v200, v72, s[80:81]
    v_cndmask_b32 v73, v201, v73, s[82:83]
    s_waitcnt lgkmcnt(4)
    v_mfma_f32_32x32x16_bf16 v[112:127], v[208:211], v[224:227], 0
    ds_read_b128 v[240:243], v250 offset:12288
    ds_read_b128 v[244:247], v251 offset:12288
    v_cndmask_b32 v74, v202, v74, s[84:85]
    v_cndmask_b32 v75, v203, v75, s[86:87]
    v_cndmask_b32 v76, v204, v76, s[88:89]
    v_cndmask_b32 v77, v205, v77, s[90:91]
    v_cndmask_b32 v78, v206, v78, s[92:93]
    v_mfma_f32_32x32x16_bf16 v[112:127], v[212:215], v[228:231], v[112:127]
    v_cndmask_b32 v79, v207, v79, s[94:95]
    v_max_f32 v248, v80, v81
    v_max_f32 v249, v82, v83
    v_max3_f32 v248, v84, v85, v248
    v_max3_f32 v249, v86, v87, v249
    s_waitcnt lgkmcnt(4)
    v_mfma_f32_32x32x16_bf16 v[128:143], v[216:219], v[224:227], 0
    ds_read_b128 v[208:211], v250 offset:14336
    ds_read_b128 v[212:215], v251 offset:14336
    v_max3_f32 v248, v88, v89, v248
    v_max3_f32 v249, v90, v91, v249
    v_max3_f32 v248, v92, v93, v248
    v_max3_f32 v249, v94, v95, v249
    v_max3_f32 v248, v64, v65, v248
    v_mfma_f32_32x32x16_bf16 v[128:143], v[220:223], v[228:231], v[128:143]
    v_max3_f32 v249, v66, v67, v249
    v_max3_f32 v248, v68, v69, v248
    v_max3_f32 v249, v70, v71, v249
    v_max3_f32 v248, v72, v73, v248
    v_max3_f32 v249, v74, v75, v249
    s_waitcnt lgkmcnt(4)
    v_mfma_f32_32x32x16_bf16 v[144:159], v[232:235], v[224:227], 0
    v_max3_f32 v248, v76, v77, v248
    v_max3_f32 v249, v78, v79, v249
    v_max3_f32 v248, v96, v97, v248
    v_max3_f32 v249, v98, v99, v249
    v_max3_f32 v248, v100, v101, v248
    v_mfma_f32_32x32x16_bf16 v[144:159], v[236:239], v[228:231], v[144:159]
    v_max3_f32 v249, v102, v103, v249
    v_max3_f32 v248, v104, v105, v248
    v_max3_f32 v249, v106, v107, v249
    v_max3_f32 v248, v108, v109, v248
    v_max3_f32 v249, v110, v111, v249
    s_waitcnt lgkmcnt(2)
    v_mfma_f32_32x32x16_bf16 v[160:175], v[240:243], v[224:227], 0
    v_max3_f32 v248, v112, v113, v248
    v_max3_f32 v249, v114, v115, v249
    v_max3_f32 v248, v116, v117, v248
    v_max3_f32 v249, v118, v119, v249
    v_max3_f32 v248, v120, v121, v248
    v_mfma_f32_32x32x16_bf16 v[160:175], v[244:247], v[228:231], v[160:175]
    v_max3_f32 v249, v122, v123, v249
    v_max3_f32 v248, v124, v125, v248
    v_max3_f32 v249, v126, v127, v249
    v_max3_f32 v248, v128, v129, v248
    v_max3_f32 v249, v130, v131, v249
    s_waitcnt lgkmcnt(0)
    v_mfma_f32_32x32x16_bf16 v[176:191], v[208:211], v[224:227], 0
    v_max3_f32 v248, v132, v133, v248
    v_max3_f32 v249, v134, v135, v249
    v_max3_f32 v248, v136, v137, v248
    v_max3_f32 v249, v138, v139, v249
    v_max3_f32 v248, v140, v141, v248
    v_mfma_f32_32x32x16_bf16 v[176:191], v[212:215], v[228:231], v[176:191]
    v_max3_f32 v249, v142, v143, v249
    v_max3_f32 v248, v144, v145, v248
    v_max3_f32 v249, v146, v147, v249
    v_max3_f32 v248, v148, v149, v248
    v_max3_f32 v249, v150, v151, v249
    v_max3_f32 v248, v152, v153, v248
    v_max3_f32 v249, v154, v155, v249
    v_max3_f32 v248, v156, v157, v248
    v_max3_f32 v249, v158, v159, v249
    v_max3_f32 v248, v160, v161, v248
    v_max3_f32 v249, v162, v163, v249
    v_max3_f32 v248, v164, v165, v248
    v_max3_f32 v249, v166, v167, v249
    v_max3_f32 v248, v168, v169, v248
    v_max3_f32 v249, v170, v171, v249
    v_max3_f32 v248, v172, v173, v248
    v_max3_f32 v249, v174, v175, v249
    ds_read_b64_tr_b16 v[240:241], v252 offset:26624
    ds_read_b64_tr_b16 v[242:243], v253 offset:26624
    ds_read_b64_tr_b16 v[244:245], v252 offset:26880
    ds_read_b64_tr_b16 v[246:247], v253 offset:26880
    v_max3_f32 v248, v176, v177, v248
    v_max3_f32 v249, v178, v179, v249
    v_max3_f32 v248, v180, v181, v248
    v_max3_f32 v249, v182, v183, v249
    v_max3_f32 v248, v184, v185, v248
    v_max3_f32 v249, v186, v187, v249
    v_max3_f32 v248, v188, v189, v248
    v_max3_f32 v249, v190, v191, v249
    v_max_f32 v248, v248, v249
    v_mov_b32 v249, v248
    s_nop 1
    v_permlane32_swap_b32 v248, v249
    v_max_f32 v248, v248, v249
    v_sub_f32 v80, v80, v248
    v_sub_f32 v81, v81, v248
    v_sub_f32 v82, v82, v248
    v_sub_f32 v83, v83, v248
    v_sub_f32 v84, v84, v248
    v_sub_f32 v85, v85, v248
    v_sub_f32 v86, v86, v248
    v_sub_f32 v87, v87, v248
    v_sub_f32 v88, v88, v248
    v_sub_f32 v89, v89, v248
    v_sub_f32 v90, v90, v248
    v_sub_f32 v91, v91, v248
    v_sub_f32 v92, v92, v248
    v_sub_f32 v93, v93, v248
    v_sub_f32 v94, v94, v248
    v_sub_f32 v95, v95, v248
    v_exp_f32 v80, v80
    v_exp_f32 v81, v81
    v_exp_f32 v82, v82
    v_exp_f32 v83, v83
    v_exp_f32 v84, v84
    v_exp_f32 v85, v85
    v_exp_f32 v86, v86
    v_exp_f32 v87, v87
    v_exp_f32 v88, v88
    v_exp_f32 v89, v89
    v_exp_f32 v90, v90
    v_exp_f32 v91, v91
    v_exp_f32 v92, v92
    v_exp_f32 v93, v93
    v_exp_f32 v94, v94
    v_exp_f32 v95, v95
    ds_read_b64_tr_b16 v[232:233], v252 offset:28672
    ds_read_b64_tr_b16 v[234:235], v253 offset:28672
    ds_read_b64_tr_b16 v[236:237], v252 offset:28928
    ds_read_b64_tr_b16 v[238:239], v253 offset:28928
    v_cvt_pk_bf16_f32 v80, v80, v81
    v_cvt_pk_bf16_f32 v81, v82, v83
    v_cvt_pk_bf16_f32 v82, v84, v85
    v_cvt_pk_bf16_f32 v83, v86, v87
    v_cvt_pk_bf16_f32 v84, v88, v89
    v_cvt_pk_bf16_f32 v85, v90, v91
    v_cvt_pk_bf16_f32 v86, v92, v93
    v_cvt_pk_bf16_f32 v87, v94, v95
    v_sub_f32 v96, v96, v248
    v_sub_f32 v97, v97, v248
    v_sub_f32 v98, v98, v248
    v_sub_f32 v99, v99, v248
    v_sub_f32 v100, v100, v248
    v_sub_f32 v101, v101, v248
    v_sub_f32 v102, v102, v248
    v_sub_f32 v103, v103, v248
    v_sub_f32 v104, v104, v248
    v_sub_f32 v105, v105, v248
    v_sub_f32 v106, v106, v248
    v_sub_f32 v107, v107, v248
    v_sub_f32 v108, v108, v248
    v_sub_f32 v109, v109, v248
    v_sub_f32 v110, v110, v248
    v_sub_f32 v111, v111, v248
    s_waitcnt lgkmcnt(4)
    v_mfma_f32_32x32x16_bf16 v[208:223], v[240:243], v[80:83], 0
    v_exp_f32 v96, v96
    v_exp_f32 v97, v97
    v_exp_f32 v98, v98
    v_exp_f32 v99, v99
    v_exp_f32 v100, v100
    v_exp_f32 v101, v101
    v_exp_f32 v102, v102
    v_exp_f32 v103, v103
    v_mfma_f32_32x32x16_bf16 v[208:223], v[244:247], v[84:87], v[208:223]
    v_exp_f32 v104, v104
    v_exp_f32 v105, v105
    v_exp_f32 v106, v106
    v_exp_f32 v107, v107
    v_exp_f32 v108, v108
    v_exp_f32 v109, v109
    v_exp_f32 v110, v110
    v_exp_f32 v111, v111
    ds_read_b64_tr_b16 v[240:241], v252 offset:30720
    ds_read_b64_tr_b16 v[242:243], v253 offset:30720
    ds_read_b64_tr_b16 v[244:245], v252 offset:30976
    ds_read_b64_tr_b16 v[246:247], v253 offset:30976
    v_cvt_pk_bf16_f32 v96, v96, v97
    v_cvt_pk_bf16_f32 v97, v98, v99
    v_cvt_pk_bf16_f32 v98, v100, v101
    v_cvt_pk_bf16_f32 v99, v102, v103
    v_cvt_pk_bf16_f32 v100, v104, v105
    v_cvt_pk_bf16_f32 v101, v106, v107
    v_cvt_pk_bf16_f32 v102, v108, v109
    v_cvt_pk_bf16_f32 v103, v110, v111
    v_sub_f32 v112, v112, v248
    v_sub_f32 v113, v113, v248
    v_sub_f32 v114, v114, v248
    v_sub_f32 v115, v115, v248
    v_sub_f32 v116, v116, v248
    v_sub_f32 v117, v117, v248
    v_sub_f32 v118, v118, v248
    v_sub_f32 v119, v119, v248
    v_sub_f32 v120, v120, v248
    v_sub_f32 v121, v121, v248
    v_sub_f32 v122, v122, v248
    v_sub_f32 v123, v123, v248
    v_sub_f32 v124, v124, v248
    v_sub_f32 v125, v125, v248
    v_sub_f32 v126, v126, v248
    v_sub_f32 v127, v127, v248
    s_cmp_eq_u32 s51, 1
    s_cbranch_scc1 L_noh_29
    v_mov_b32 v4, 161816
    v_mov_b32 v5, 1
    s_mov_b64 exec, 1
    s_waitcnt vmcnt(0)
    ds_add_rtn_u32 v5, v4, v5
    s_mov_b64 exec, -1
    s_waitcnt lgkmcnt(0)
    v_readfirstlane_b32 s60, v5
    s_nop 0
    s_cmp_lg_u32 s60, 3
    s_cbranch_scc1 L_ws_30
    s_add_u32 s60, s7, 1114240
    s_bfm_b64 exec, 14, 0
    buffer_store_dword v6, v7, s[36:39], s60 offen sc1
    s_mov_b64 exec, -1
L_ws_30:
L_noh_29:
    s_waitcnt lgkmcnt(4)
    v_mfma_f32_32x32x16_bf16 v[208:223], v[232:235], v[96:99], v[208:223]
    v_exp_f32 v112, v112
    v_exp_f32 v113, v113
    v_exp_f32 v114, v114
    v_exp_f32 v115, v115
    v_exp_f32 v116, v116
    v_exp_f32 v117, v117
    v_exp_f32 v118, v118
    v_exp_f32 v119, v119
    v_mfma_f32_32x32x16_bf16 v[208:223], v[236:239], v[100:103], v[208:223]
    v_exp_f32 v120, v120
    v_exp_f32 v121, v121
    v_exp_f32 v122, v122
    v_exp_f32 v123, v123
    v_exp_f32 v124, v124
    v_exp_f32 v125, v125
    v_exp_f32 v126, v126
    v_exp_f32 v127, v127
    ds_read_b64_tr_b16 v[232:233], v252 offset:32768
    ds_read_b64_tr_b16 v[234:235], v253 offset:32768
    ds_read_b64_tr_b16 v[236:237], v252 offset:33024
    ds_read_b64_tr_b16 v[238:239], v253 offset:33024
    v_cvt_pk_bf16_f32 v112, v112, v113
    v_cvt_pk_bf16_f32 v113, v114, v115
    v_cvt_pk_bf16_f32 v114, v116, v117
    v_cvt_pk_bf16_f32 v115, v118, v119
    v_cvt_pk_bf16_f32 v116, v120, v121
    v_cvt_pk_bf16_f32 v117, v122, v123
    v_cvt_pk_bf16_f32 v118, v124, v125
    v_cvt_pk_bf16_f32 v119, v126, v127
    v_sub_f32 v128, v128, v248
    v_sub_f32 v129, v129, v248
    v_sub_f32 v130, v130, v248
    v_sub_f32 v131, v131, v248
    v_sub_f32 v132, v132, v248
    v_sub_f32 v133, v133, v248
    v_sub_f32 v134, v134, v248
    v_sub_f32 v135, v135, v248
    v_sub_f32 v136, v136, v248
    v_sub_f32 v137, v137, v248
    v_sub_f32 v138, v138, v248
    v_sub_f32 v139, v139, v248
    v_sub_f32 v140, v140, v248
    v_sub_f32 v141, v141, v248
    v_sub_f32 v142, v142, v248
    v_sub_f32 v143, v143, v248
    s_waitcnt lgkmcnt(4)
    v_mfma_f32_32x32x16_bf16 v[208:223], v[240:243], v[112:115], v[208:223]
    v_exp_f32 v128, v128
    v_exp_f32 v129, v129
    v_exp_f32 v130, v130
    v_exp_f32 v131, v131
    v_exp_f32 v132, v132
    v_exp_f32 v133, v133
    v_exp_f32 v134, v134
    v_exp_f32 v135, v135
    v_mfma_f32_32x32x16_bf16 v[208:223], v[244:247], v[116:119], v[208:223]
    v_exp_f32 v136, v136
    v_exp_f32 v137, v137
    v_exp_f32 v138, v138
    v_exp_f32 v139, v139
    v_exp_f32 v140, v140
    v_exp_f32 v141, v141
    v_exp_f32 v142, v142
    v_exp_f32 v143, v143
    ds_read_b64_tr_b16 v[240:241], v252 offset:34816
    ds_read_b64_tr_b16 v[242:243], v253 offset:34816
    ds_read_b64_tr_b16 v[244:245], v252 offset:35072
    ds_read_b64_tr_b16 v[246:247], v253 offset:35072
    v_cvt_pk_bf16_f32 v128, v128, v129
    v_cvt_pk_bf16_f32 v129, v130, v131
    v_cvt_pk_bf16_f32 v130, v132, v133
    v_cvt_pk_bf16_f32 v131, v134, v135
    v_cvt_pk_bf16_f32 v132, v136, v137
    v_cvt_pk_bf16_f32 v133, v138, v139
    v_cvt_pk_bf16_f32 v134, v140, v141
    v_cvt_pk_bf16_f32 v135, v142, v143
    v_sub_f32 v144, v144, v248
    v_sub_f32 v145, v145, v248
    v_sub_f32 v146, v146, v248
    v_sub_f32 v147, v147, v248
    v_sub_f32 v148, v148, v248
    v_sub_f32 v149, v149, v248
    v_sub_f32 v150, v150, v248
    v_sub_f32 v151, v151, v248
    v_sub_f32 v152, v152, v248
    v_sub_f32 v153, v153, v248
    v_sub_f32 v154, v154, v248
    v_sub_f32 v155, v155, v248
    v_sub_f32 v156, v156, v248
    v_sub_f32 v157, v157, v248
    v_sub_f32 v158, v158, v248
    v_sub_f32 v159, v159, v248
    s_waitcnt lgkmcnt(4)
    v_mfma_f32_32x32x16_bf16 v[208:223], v[232:235], v[128:131], v[208:223]
    v_exp_f32 v144, v144
    v_exp_f32 v145, v145
    v_exp_f32 v146, v146
    v_exp_f32 v147, v147
    v_exp_f32 v148, v148
    v_exp_f32 v149, v149
    v_exp_f32 v150, v150
    v_exp_f32 v151, v151
    v_mfma_f32_32x32x16_bf16 v[208:223], v[236:239], v[132:135], v[208:223]
    v_exp_f32 v152, v152
    v_exp_f32 v153, v153
    v_exp_f32 v154, v154
    v_exp_f32 v155, v155
    v_exp_f32 v156, v156
    v_exp_f32 v157, v157
    v_exp_f32 v158, v158
    v_exp_f32 v159, v159
    ds_read_b64_tr_b16 v[232:233], v252 offset:36864
    ds_read_b64_tr_b16 v[234:235], v253 offset:36864
    ds_read_b64_tr_b16 v[236:237], v252 offset:37120
    ds_read_b64_tr_b16 v[238:239], v253 offset:37120
    v_cvt_pk_bf16_f32 v144, v144, v145
    v_cvt_pk_bf16_f32 v145, v146, v147
    v_cvt_pk_bf16_f32 v146, v148, v149
    v_cvt_pk_bf16_f32 v147, v150, v151
    v_cvt_pk_bf16_f32 v148, v152, v153
    v_cvt_pk_bf16_f32 v149, v154, v155
    v_cvt_pk_bf16_f32 v150, v156, v157
    v_cvt_pk_bf16_f32 v151, v158, v159
    v_sub_f32 v160, v160, v248
    v_sub_f32 v161, v161, v248
    v_sub_f32 v162, v162, v248
    v_sub_f32 v163, v163, v248
    v_sub_f32 v164, v164, v248
    v_sub_f32 v165, v165, v248
    v_sub_f32 v166, v166, v248
    v_sub_f32 v167, v167, v248
    v_sub_f32 v168, v168, v248
    v_sub_f32 v169, v169, v248
    v_sub_f32 v170, v170, v248
    v_sub_f32 v171, v171, v248
    v_sub_f32 v172, v172, v248
    v_sub_f32 v173, v173, v248
    v_sub_f32 v174, v174, v248
    v_sub_f32 v175, v175, v248
    s_waitcnt lgkmcnt(4)
    v_mfma_f32_32x32x16_bf16 v[208:223], v[240:243], v[144:147], v[208:223]
    v_exp_f32 v160, v160
    v_exp_f32 v161, v161
    v_exp_f32 v162, v162
    v_exp_f32 v163, v163
    v_exp_f32 v164, v164
    v_exp_f32 v165, v165
    v_exp_f32 v166, v166
    v_exp_f32 v167, v167
    v_mfma_f32_32x32x16_bf16 v[208:223], v[244:247], v[148:151], v[208:223]
    v_exp_f32 v168, v168
    v_exp_f32 v169, v169
    v_exp_f32 v170, v170
    v_exp_f32 v171, v171
    v_exp_f32 v172, v172
    v_exp_f32 v173, v173
    v_exp_f32 v174, v174
    v_exp_f32 v175, v175
    ds_read_b64_tr_b16 v[240:241], v252 offset:38912
    ds_read_b64_tr_b16 v[242:243], v253 offset:38912
    ds_read_b64_tr_b16 v[244:245], v252 offset:39168
    ds_read_b64_tr_b16 v[246:247], v253 offset:39168
    v_cvt_pk_bf16_f32 v160, v160, v161
    v_cvt_pk_bf16_f32 v161, v162, v163
    v_cvt_pk_bf16_f32 v162, v164, v165
    v_cvt_pk_bf16_f32 v163, v166, v167
    v_cvt_pk_bf16_f32 v164, v168, v169
    v_cvt_pk_bf16_f32 v165, v170, v171
    v_cvt_pk_bf16_f32 v166, v172, v173
    v_cvt_pk_bf16_f32 v167, v174, v175
    v_sub_f32 v176, v176, v248
    v_sub_f32 v177, v177, v248
    v_sub_f32 v178, v178, v248
    v_sub_f32 v179, v179, v248
    v_sub_f32 v180, v180, v248
    v_sub_f32 v181, v181, v248
    v_sub_f32 v182, v182, v248
    v_sub_f32 v183, v183, v248
    v_sub_f32 v184, v184, v248
    v_sub_f32 v185, v185, v248
    v_sub_f32 v186, v186, v248
    v_sub_f32 v187, v187, v248
    v_sub_f32 v188, v188, v248
    v_sub_f32 v189, v189, v248
    v_sub_f32 v190, v190, v248
    v_sub_f32 v191, v191, v248
    s_waitcnt lgkmcnt(4)
    v_mfma_f32_32x32x16_bf16 v[208:223], v[232:235], v[160:163], v[208:223]
    v_exp_f32 v176, v176
    v_exp_f32 v177, v177
    v_exp_f32 v178, v178
    v_exp_f32 v179, v179
    v_exp_f32 v180, v180
    v_exp_f32 v181, v181
    v_exp_f32 v182, v182
    v_exp_f32 v183, v183
    v_mfma_f32_32x32x16_bf16 v[208:223], v[236:239], v[164:167], v[208:223]
    v_exp_f32 v184, v184
    v_exp_f32 v185, v185
    v_exp_f32 v186, v186
    v_exp_f32 v187, v187
    v_exp_f32 v188, v188
    v_exp_f32 v189, v189
    v_exp_f32 v190, v190
    v_exp_f32 v191, v191
    ds_read_b64_tr_b16 v[232:233], v252 offset:24576
    ds_read_b64_tr_b16 v[234:235], v253 offset:24576
    ds_read_b64_tr_b16 v[236:237], v252 offset:24832
    ds_read_b64_tr_b16 v[238:239], v253 offset:24832
    v_cvt_pk_bf16_f32 v176, v176, v177
    v_cvt_pk_bf16_f32 v177, v178, v179
    v_cvt_pk_bf16_f32 v178, v180, v181
    v_cvt_pk_bf16_f32 v179, v182, v183
    v_cvt_pk_bf16_f32 v180, v184, v185
    v_cvt_pk_bf16_f32 v181, v186, v187
    v_cvt_pk_bf16_f32 v182, v188, v189
    v_cvt_pk_bf16_f32 v183, v190, v191
    v_sub_f32 v64, v64, v248
    v_sub_f32 v65, v65, v248
    v_sub_f32 v66, v66, v248
    v_sub_f32 v67, v67, v248
    v_sub_f32 v68, v68, v248
    v_sub_f32 v69, v69, v248
    v_sub_f32 v70, v70, v248
    v_sub_f32 v71, v71, v248
    v_sub_f32 v72, v72, v248
    v_sub_f32 v73, v73, v248
    v_sub_f32 v74, v74, v248
    v_sub_f32 v75, v75, v248
    v_sub_f32 v76, v76, v248
    v_sub_f32 v77, v77, v248
    v_sub_f32 v78, v78, v248
    v_sub_f32 v79, v79, v248
    s_waitcnt lgkmcnt(4)
    v_mfma_f32_32x32x16_bf16 v[208:223], v[240:243], v[176:179], v[208:223]
    v_exp_f32 v64, v64
    v_exp_f32 v65, v65
    v_exp_f32 v66, v66
    v_exp_f32 v67, v67
    v_exp_f32 v68, v68
    v_exp_f32 v69, v69
    v_exp_f32 v70, v70
    v_exp_f32 v71, v71
    v_mfma_f32_32x32x16_bf16 v[208:223], v[244:247], v[180:183], v[208:223]
    v_exp_f32 v72, v72
    v_exp_f32 v73, v73
    v_exp_f32 v74, v74
    v_exp_f32 v75, v75
    v_exp_f32 v76, v76
    v_exp_f32 v77, v77
    v_exp_f32 v78, v78
    v_exp_f32 v79, v79
    ds_read_b64_tr_b16 v[240:241], v252 offset:40960
    ds_read_b64_tr_b16 v[242:243], v253 offset:40960
    ds_read_b64_tr_b16 v[244:245], v252 offset:41216
    ds_read_b64_tr_b16 v[246:247], v253 offset:41216
    v_cvt_pk_bf16_f32 v64, v64, v65
    v_cvt_pk_bf16_f32 v65, v66, v67
    v_cvt_pk_bf16_f32 v66, v68, v69
    v_cvt_pk_bf16_f32 v67, v70, v71
    v_cvt_pk_bf16_f32 v68, v72, v73
    v_cvt_pk_bf16_f32 v69, v74, v75
    v_cvt_pk_bf16_f32 v70, v76, v77
    v_cvt_pk_bf16_f32 v71, v78, v79
    v_bfi_b32 v72, v56, 0, v64
    v_and_b32 v64, v56, v64
    v_bfi_b32 v73, v57, 0, v65
    v_and_b32 v65, v57, v65
    v_bfi_b32 v74, v58, 0, v66
    v_and_b32 v66, v58, v66
    v_bfi_b32 v75, v59, 0, v67
    v_and_b32 v67, v59, v67
    v_bfi_b32 v76, v60, 0, v68
    v_and_b32 v68, v60, v68
    v_bfi_b32 v77, v61, 0, v69
    v_and_b32 v69, v61, v69
    v_bfi_b32 v78, v62, 0, v70
    v_and_b32 v70, v62, v70
    v_bfi_b32 v79, v63, 0, v71
    v_and_b32 v71, v63, v71
    s_waitcnt lgkmcnt(4)
    v_mfma_f32_32x32x16_bf16 v[208:223], v[232:235], v[64:67], v[208:223]
    v_mfma_f32_32x32x16_bf16 v[208:223], v[236:239], v[68:71], v[208:223]
    s_waitcnt lgkmcnt(0)
    v_mfma_f32_32x32x16_bf16 v[208:223], v[240:243], v[72:75], v[208:223]
    v_mfma_f32_32x32x16_bf16 v[208:223], v[244:247], v[76:79], v[208:223]
    s_cmp_eq_u32 s53, 1
    s_cselect_b64 s[54:55], -1, 0
    s_cselect_b32 s56, -1, 0
    s_mov_b32 s57, 0
    s_mov_b32 s58, 0
    s_cselect_b32 s59, 0, -1
    s_lshl2_add_u32 s61, s49, s41
    s_lshl_b32 s60, s61, 15
    s_lshl_b32 s62, s48, 11
    s_add_u32 s62, s60, s62
    s_add_u32 s62, s62, 14680064
    s_lshr_b32 s63, s48, 3
    s_lshl4_add_u32 s3, s63, s49
    s_mul_i32 s3, s3, 60928
    s_and_b32 s63, s48, 7
    s_lshl2_add_u32 s3, s63, s3
    s_add_u32 s3, s3, 20250624
    v_mul_u32_u24 v7, 4352, v0
    v_lshlrev_b32 v16, 4, v0
    v_cndmask_b32 v8, v220, v208, s[54:55]
    v_mov_b32 v9, v8
    s_nop 1
    v_permlane32_swap_b32 v8, v9
    v_cndmask_b32 v8, v9, v8, s[54:55]
    v_rcp_f32 v8, v8
    s_nop 0
    v_cndmask_b32 v10, v8, 0, s[56:57]
    v_cndmask_b32 v12, v8, 0, s[58:59]
    v_mul_f32 v208, v208, v10
    v_mul_f32 v209, v209, v10
    v_mul_f32 v210, v210, v10
    v_mul_f32 v211, v211, v10
    v_mul_f32 v212, v212, v8
    v_mul_f32 v213, v213, v8
    v_mul_f32 v214, v214, v8
    v_mul_f32 v215, v215, v8
    v_mul_f32 v216, v216, v8
    v_mul_f32 v217, v217, v8
    v_mul_f32 v218, v218, v8
    v_mul_f32 v219, v219, v8
    v_mul_f32 v220, v220, v12
    v_mul_f32 v221, v221, v12
    v_mul_f32 v222, v222, v12
    v_mul_f32 v223, v223, v12
    v_cvt_pk_bf16_f32 v208, v208, v209
    v_cvt_pk_bf16_f32 v209, v210, v211
    v_cvt_pk_bf16_f32 v210, v212, v213
    v_cvt_pk_bf16_f32 v211, v214, v215
    v_cvt_pk_bf16_f32 v212, v216, v217
    v_cvt_pk_bf16_f32 v213, v218, v219
    v_cvt_pk_bf16_f32 v214, v220, v221
    v_cvt_pk_bf16_f32 v215, v222, v223
    buffer_store_dwordx4 v[208:211], v16, s[36:39], s62 offen offset:0 sc1
    buffer_store_dwordx4 v[212:215], v16, s[36:39], s62 offen offset:1024 sc1
    s_cmp_eq_u32 s51, 0
    s_cbranch_scc1 L_wk_31
    v_mov_b32 v4, 161820
    v_mov_b32 v5, 1
    s_mov_b64 exec, 1
    s_waitcnt vmcnt(0)
    ds_add_rtn_u32 v5, v4, v5
    s_mov_b64 exec, -1
    s_waitcnt lgkmcnt(0)
    v_readfirstlane_b32 s60, v5
    s_nop 0
    s_cmp_lg_u32 s60, 3
    s_cbranch_scc1 L_ws_32
    s_add_u32 s60, s3, 0
    s_bfm_b64 exec, 14, 0
    buffer_store_dword v6, v7, s[36:39], s60 offen sc1
    s_mov_b64 exec, -1
L_ws_32:
    s_branch L_fin
L_wk_31:
    s_and_b32 s55, s41, 1
    s_lshl3_add_u32 s54, s55, 161824
    v_mov_b32 v250, s54
    s_mul_i32 s56, s55, 28672
    s_add_u32 s56, s56, 57344
    v_lshrrev_b32 v28, 5, v0
    v_lshlrev_b32 v28, 3, v28
    v_bfe_u32 v30, v0, 2, 2
    v_add_u32 v28, v28, v30
    v_bfe_u32 v29, v0, 4, 1
    v_lshlrev_b32 v29, 5, v29
    v_and_b32 v31, 1, v0
    v_lshl_or_b32 v29, v31, 4, v29
    v_bfe_u32 v31, v0, 1, 1
    v_lshl_or_b32 v29, v31, 3, v29
    v_lshlrev_b32 v246, 7, v28
    v_add_u32 v246, v246, v29
    v_lshrrev_b32 v30, 1, v30
    v_lshl_or_b32 v246, v30, 6, v246
    v_add_u32 v246, s56, v246
    v_xor_b32 v247, 64, v246
    s_lshl_b32 s56, s55, 14
    s_lshr_b32 s54, s41, 1
    s_lshl_b32 s54, s54, 9
    s_add_u32 s56, s56, s54
    s_and_b32 s63, s47, 0
    s_mul_i32 s54, s63, 14336
    s_sub_u32 s55, 14336, s54
    v_add_u32 v248, s55, v246
    v_add_u32 v249, s55, v247
    v_add_u32 v246, s54, v246
    v_add_u32 v247, s54, v247
    s_lshl_b32 s63, s63, 13
    v_and_b32 v24, 31, v0
    v_lshrrev_b32 v25, 5, v0
    v_lshlrev_b32 v26, 1, v25
    v_xor_b32 v24, v24, v26
    v_lshlrev_b32 v24, 4, v24
    v_lshl_or_b32 v24, v25, 10, v24
    v_add_u32 v24, s56, v24
    v_xor_b32 v25, 64, v24
    v_xor_b32 v26, 0x80, v24
    v_xor_b32 v27, 0xc0, v24
    s_lshl_b32 s60, s46, 3
    s_add_u32 s60, s60, s40
    s_mul_i32 s60, s60, 7168
    s_lshl_b32 s54, s47, 7
    s_add_u32 s60, s60, s54
    v_lshrrev_b32 v244, 3, v0
    v_mul_u32_u24 v244, 896, v244
    v_and_b32 v245, 7, v0
    v_lshl_add_u32 v244, v245, 4, v244
    v_add_u32 v244, s60, v244
    v_mov_b32 v4, 161820
    v_mov_b32 v5, 1
    s_mov_b64 exec, 1
    s_waitcnt vmcnt(0)
    ds_add_rtn_u32 v5, v4, v5
    s_mov_b64 exec, -1
    s_waitcnt lgkmcnt(0)
    v_readfirstlane_b32 s60, v5
    s_nop 0
    s_cmp_lg_u32 s60, 3
    s_cbranch_scc1 L_ws_33
    s_add_u32 s60, s3, 0
    s_bfm_b64 exec, 14, 0
    buffer_store_dword v6, v7, s[36:39], s60 offen sc1
    s_mov_b64 exec, -1
L_ws_33:
    buffer_load_dwordx4 v[240:243], v244, s[8:11], 0 offen
L_wordy_34:
    ds_read_b64 v[2:3], v250
    s_waitcnt lgkmcnt(0)
    v_and_b32 v2, v2, v3
    s_nop 0
    v_readfirstlane_b32 s60, v2
    s_nop 0
    s_cmp_lg_u32 s60, 0
    s_cbranch_scc1 L_wordy_34ok
    s_sleep 1
    s_branch L_wordy_34
L_wordy_34ok:
    v_readfirstlane_b32 s100, v6
    s_lshl2_add_u32 s58, s46, s41
    s_lshl_b32 s57, s58, 14
    s_add_u32 s57, s57, 14680064
    s_xor_b32 s57, s57, s63
    s_and_b32 s58, s41, 1
    s_lshl_b32 s58, s58, 5
    s_add_u32 s58, s58, s46
    s_mul_i32 s58, s58, 7
    s_add_u32 s58, s58, s47
    s_mul_i32 s58, s58, 4352
    s_add_u32 s58, s58, 20250624
    s_mov_b32 s101, s100
    ds_read_b64_tr_b16 v[32:33], v246 offset:0
    ds_read_b64_tr_b16 v[34:35], v246 offset:512
    ds_read_b64_tr_b16 v[36:37], v247 offset:0
    ds_read_b64_tr_b16 v[38:39], v247 offset:512
    ds_read_b64_tr_b16 v[40:41], v246 offset:2048
    ds_read_b64_tr_b16 v[42:43], v246 offset:2560
    ds_read_b64_tr_b16 v[44:45], v247 offset:2048
    ds_read_b64_tr_b16 v[46:47], v247 offset:2560
    ds_read_b64_tr_b16 v[48:49], v246 offset:3072
    ds_read_b64_tr_b16 v[50:51], v246 offset:3584
    ds_read_b64_tr_b16 v[52:53], v247 offset:3072
    ds_read_b64_tr_b16 v[54:55], v247 offset:3584
    ds_read_b64_tr_b16 v[56:57], v246 offset:5120
    ds_read_b64_tr_b16 v[58:59], v246 offset:5632
    ds_read_b64_tr_b16 v[60:61], v247 offset:5120
    ds_read_b64_tr_b16 v[62:63], v247 offset:5632
    ds_read_b64_tr_b16 v[64:65], v246 offset:7168
    ds_read_b64_tr_b16 v[66:67], v246 offset:7680
    ds_read_b64_tr_b16 v[68:69], v247 offset:7168
    ds_read_b64_tr_b16 v[70:71], v247 offset:7680
    ds_read_b64_tr_b16 v[72:73], v246 offset:9216
    ds_read_b64_tr_b16 v[74:75], v246 offset:9728
    ds_read_b64_tr_b16 v[76:77], v247 offset:9216
    ds_read_b64_tr_b16 v[78:79], v247 offset:9728
    ds_read_b64_tr_b16 v[80:81], v246 offset:10240
    ds_read_b64_tr_b16 v[82:83], v246 offset:10752
    ds_read_b64_tr_b16 v[84:85], v247 offset:10240
    ds_read_b64_tr_b16 v[86:87], v247 offset:10752
    ds_read_b64_tr_b16 v[88:89], v246 offset:12288
    ds_read_b64_tr_b16 v[90:91], v246 offset:12800
    ds_read_b64_tr_b16 v[92:93], v247 offset:12288
    ds_read_b64_tr_b16 v[94:95], v247 offset:12800
    s_load_dwordx8 s[64:71], s[36:37], s58 glc
    ds_read_b64_tr_b16 v[96:97], v248 offset:0
    ds_read_b64_tr_b16 v[98:99], v248 offset:512
    ds_read_b64_tr_b16 v[100:101], v249 offset:0
    ds_read_b64_tr_b16 v[102:103], v249 offset:512
    ds_read_b64_tr_b16 v[104:105], v248 offset:2048
    ds_read_b64_tr_b16 v[106:107], v248 offset:2560
    ds_read_b64_tr_b16 v[108:109], v249 offset:2048
    ds_read_b64_tr_b16 v[110:111], v249 offset:2560
    ds_read_b64_tr_b16 v[112:113], v248 offset:3072
    ds_read_b64_tr_b16 v[114:115], v248 offset:3584
    ds_read_b64_tr_b16 v[116:117], v249 offset:3072
    ds_read_b64_tr_b16 v[118:119], v249 offset:3584
    ds_read_b64_tr_b16 v[120:121], v248 offset:5120
    ds_read_b64_tr_b16 v[122:123], v248 offset:5632
    ds_read_b64_tr_b16 v[124:125], v249 offset:5120
    ds_read_b64_tr_b16 v[126:127], v249 offset:5632
    ds_read_b64_tr_b16 v[128:129], v248 offset:7168
    ds_read_b64_tr_b16 v[130:131], v248 offset:7680
    ds_read_b64_tr_b16 v[132:133], v249 offset:7168
    ds_read_b64_tr_b16 v[134:135], v249 offset:7680
    ds_read_b64_tr_b16 v[136:137], v248 offset:9216
    ds_read_b64_tr_b16 v[138:139], v248 offset:9728
    ds_read_b64_tr_b16 v[140:141], v249 offset:9216
    ds_read_b64_tr_b16 v[142:143], v249 offset:9728
    ds_read_b64_tr_b16 v[144:145], v248 offset:10240
    ds_read_b64_tr_b16 v[146:147], v248 offset:10752
    ds_read_b64_tr_b16 v[148:149], v249 offset:10240
    ds_read_b64_tr_b16 v[150:151], v249 offset:10752
    ds_read_b64_tr_b16 v[152:153], v248 offset:12288
    ds_read_b64_tr_b16 v[154:155], v248 offset:12800
    ds_read_b64_tr_b16 v[156:157], v249 offset:12288
    ds_read_b64_tr_b16 v[158:159], v249 offset:12800
    v_mov_b32 v250, 161792
    v_mov_b32 v251, 1
    s_mov_b64 exec, 1
    ds_add_u32 v250, v251
    s_mov_b64 exec, -1
    v_lshlrev_b32 v252, 4, v0
    s_add_u32 s59, s57, 4096
    s_xor_b32 s62, s57, 8192
    s_xor_b32 s63, s59, 8192
    s_mov_b32 s60, 0
    s_branch L_spchk_37
L_sp_35:
    s_load_dwordx8 s[64:71], s[36:37], s58 glc
L_spchk_37:
    s_waitcnt lgkmcnt(0)
    s_xor_b64 s[64:65], s[64:65], s[100:101]
    s_xor_b64 s[66:67], s[66:67], s[100:101]
    s_xor_b64 s[68:69], s[68:69], s[100:101]
    s_xor_b64 s[70:71], s[70:71], s[100:101]
    s_or_b64 s[64:65], s[64:65], s[66:67]
    s_or_b64 s[64:65], s[64:65], s[68:69]
    s_or_b64 s[64:65], s[64:65], s[70:71]
    s_cbranch_scc1 L_spno_38
    s_branch L_spok_36
L_spno_38:
    s_add_u32 s60, s60, 1
    s_sleep 1
    s_cmp_lt_u32 s60, 0x10000
    s_cbranch_scc1 L_sp_35
L_spok_36:
    s_setprio 2
    buffer_load_dwordx4 v[160:163], v252, s[36:39], s57 offen offset:0 sc1
    buffer_load_dwordx4 v[164:167], v252, s[36:39], s57 offen offset:1024 sc1
    buffer_load_dwordx4 v[168:171], v252, s[36:39], s57 offen offset:2048 sc1
    buffer_load_dwordx4 v[172:175], v252, s[36:39], s57 offen offset:3072 sc1
    buffer_load_dwordx4 v[176:179], v252, s[36:39], s59 offen offset:0 sc1
    buffer_load_dwordx4 v[180:183], v252, s[36:39], s59 offen offset:1024 sc1
    buffer_load_dwordx4 v[184:187], v252, s[36:39], s59 offen offset:2048 sc1
    buffer_load_dwordx4 v[188:191], v252, s[36:39], s59 offen offset:3072 sc1
    buffer_load_dwordx4 v[192:195], v252, s[36:39], s62 offen offset:0 sc1
    buffer_load_dwordx4 v[196:199], v252, s[36:39], s62 offen offset:1024 sc1
    buffer_load_dwordx4 v[200:203], v252, s[36:39], s62 offen offset:2048 sc1
    buffer_load_dwordx4 v[204:207], v252, s[36:39], s62 offen offset:3072 sc1
    buffer_load_dwordx4 v[208:211], v252, s[36:39], s63 offen offset:0 sc1
    buffer_load_dwordx4 v[212:215], v252, s[36:39], s63 offen offset:1024 sc1
    buffer_load_dwordx4 v[216:219], v252, s[36:39], s63 offen offset:2048 sc1
    buffer_load_dwordx4 v[220:223], v252, s[36:39], s63 offen offset:3072 sc1
    s_setprio 0
L_kvfree_39:
    ds_read_b32 v251, v250
    s_waitcnt lgkmcnt(0)
    v_readfirstlane_b32 s60, v251
    s_nop 0
    s_cmp_lt_u32 s60, 4
    s_cbranch_scc1 L_kvfree_39
    s_waitcnt vmcnt(15)
    v_mfma_f32_32x32x16_bf16 v[224:239], v[32:35], v[160:163], 0
    v_mfma_f32_32x32x16_bf16 v[8:23], v[36:39], v[160:163], 0
    s_waitcnt vmcnt(14)
    v_mfma_f32_32x32x16_bf16 v[224:239], v[40:43], v[164:167], v[224:239]
    v_mfma_f32_32x32x16_bf16 v[8:23], v[44:47], v[164:167], v[8:23]
    s_waitcnt vmcnt(13)
    v_mfma_f32_32x32x16_bf16 v[224:239], v[48:51], v[168:171], v[224:239]
    v_mfma_f32_32x32x16_bf16 v[8:23], v[52:55], v[168:171], v[8:23]
    s_waitcnt vmcnt(12)
    v_mfma_f32_32x32x16_bf16 v[224:239], v[56:59], v[172:175], v[224:239]
    v_mfma_f32_32x32x16_bf16 v[8:23], v[60:63], v[172:175], v[8:23]
    s_waitcnt vmcnt(11)
    v_mfma_f32_32x32x16_bf16 v[224:239], v[64:67], v[176:179], v[224:239]
    v_mfma_f32_32x32x16_bf16 v[8:23], v[68:71], v[176:179], v[8:23]
    s_waitcnt vmcnt(10)
    v_mfma_f32_32x32x16_bf16 v[224:239], v[72:75], v[180:183], v[224:239]
    v_mfma_f32_32x32x16_bf16 v[8:23], v[76:79], v[180:183], v[8:23]
    s_waitcnt vmcnt(9)
    v_mfma_f32_32x32x16_bf16 v[224:239], v[80:83], v[184:187], v[224:239]
    v_mfma_f32_32x32x16_bf16 v[8:23], v[84:87], v[184:187], v[8:23]
    s_waitcnt vmcnt(8)
    v_mfma_f32_32x32x16_bf16 v[224:239], v[88:91], v[188:191], v[224:239]
    v_mfma_f32_32x32x16_bf16 v[8:23], v[92:95], v[188:191], v[8:23]
    s_waitcnt vmcnt(7)
    v_mfma_f32_32x32x16_bf16 v[224:239], v[96:99], v[192:195], v[224:239]
    v_mfma_f32_32x32x16_bf16 v[8:23], v[100:103], v[192:195], v[8:23]
    s_waitcnt vmcnt(6)
    v_mfma_f32_32x32x16_bf16 v[224:239], v[104:107], v[196:199], v[224:239]
    v_mfma_f32_32x32x16_bf16 v[8:23], v[108:111], v[196:199], v[8:23]
    s_waitcnt vmcnt(5)
    v_mfma_f32_32x32x16_bf16 v[224:239], v[112:115], v[200:203], v[224:239]
    v_mfma_f32_32x32x16_bf16 v[8:23], v[116:119], v[200:203], v[8:23]
    s_setprio 2
    s_waitcnt vmcnt(4)
    v_mfma_f32_32x32x16_bf16 v[224:239], v[120:123], v[204:207], v[224:239]
    s_waitcnt vmcnt(3)
    v_mfma_f32_32x32x16_bf16 v[224:239], v[128:131], v[208:211], v[224:239]
    s_waitcnt vmcnt(2)
    v_mfma_f32_32x32x16_bf16 v[224:239], v[136:139], v[212:215], v[224:239]
    s_waitcnt vmcnt(1)
    v_mfma_f32_32x32x16_bf16 v[224:239], v[144:147], v[216:219], v[224:239]
    s_waitcnt vmcnt(0)
    v_mfma_f32_32x32x16_bf16 v[224:239], v[152:155], v[220:223], v[224:239]
    v_mfma_f32_32x32x16_bf16 v[8:23], v[124:127], v[204:207], v[8:23]
    v_mfma_f32_32x32x16_bf16 v[8:23], v[132:135], v[208:211], v[8:23]
    s_nop 9
    ds_write_b128 v24, v[224:227] offset:0
    v_mfma_f32_32x32x16_bf16 v[8:23], v[140:143], v[212:215], v[8:23]
    ds_write_b128 v24, v[228:231] offset:8192
    v_mfma_f32_32x32x16_bf16 v[8:23], v[148:151], v[216:219], v[8:23]
    ds_write_b128 v25, v[232:235] offset:2048
    v_mfma_f32_32x32x16_bf16 v[8:23], v[156:159], v[220:223], v[8:23]
    ds_write_b128 v25, v[236:239] offset:10240
    s_nop 10
    ds_write_b128 v26, v[8:11] offset:4096
    ds_write_b128 v26, v[12:15] offset:12288
    ds_write_b128 v27, v[16:19] offset:6144
    ds_write_b128 v27, v[20:23] offset:14336
L_final:
    s_setprio 0
    v_lshrrev_b32 v108, 3, v0
    s_lshl_b32 s54, s40, 3
    v_add_u32 v108, s54, v108
    v_and_b32 v109, 7, v0
    v_lshlrev_b32 v110, 1, v109
    v_xor_b32 v108, v108, v110
    v_lshlrev_b32 v108, 4, v108
    v_and_b32 v110, 1, v0
    v_lshl_or_b32 v110, v110, 10, v108
    v_lshl_or_b32 v108, v109, 10, v108
    v_lshrrev_b32 v109, 1, v109
    v_lshl_or_b32 v109, v109, 13, v110
    v_add_u32 v109, 0x10000, v109
    v_mov_b32 v112, 0xbfb8aa3b
    v_mov_b32 v114, 1.0
    s_waitcnt vmcnt(0)
    v_lshlrev_b32 v96, 16, v240
    v_and_b32 v97, 0xffff0000, v240
    v_lshlrev_b32 v98, 16, v241
    v_and_b32 v99, 0xffff0000, v241
    v_lshlrev_b32 v100, 16, v242
    v_and_b32 v101, 0xffff0000, v242
    v_lshlrev_b32 v102, 16, v243
    v_and_b32 v103, 0xffff0000, v243
    s_waitcnt lgkmcnt(0)
    s_barrier
    ds_read_b128 v[32:35], v109 offset:0
    ds_read_b128 v[36:39], v109 offset:32768
    ds_read_b128 v[40:43], v109 offset:2048
    ds_read_b128 v[44:47], v109 offset:34816
    ds_read_b128 v[48:51], v109 offset:4096
    ds_read_b128 v[52:55], v109 offset:36864
    ds_read_b128 v[56:59], v109 offset:6144
    ds_read_b128 v[60:63], v109 offset:38912
    ds_read_b128 v[64:67], v108 offset:0
    ds_read_b128 v[68:71], v108 offset:8192
    ds_read_b128 v[72:75], v108 offset:16384
    ds_read_b128 v[76:79], v108 offset:24576
    s_waitcnt lgkmcnt(4)
    v_pk_add_f32 v[32:33], v[32:33], v[40:41]
    v_pk_add_f32 v[48:49], v[48:49], v[56:57]
    v_pk_add_f32 v[34:35], v[34:35], v[42:43]
    v_pk_add_f32 v[50:51], v[50:51], v[58:59]
    v_pk_add_f32 v[36:37], v[36:37], v[44:45]
    v_pk_add_f32 v[52:53], v[52:53], v[60:61]
    v_pk_add_f32 v[38:39], v[38:39], v[46:47]
    v_pk_add_f32 v[54:55], v[54:55], v[62:63]
    v_pk_add_f32 v[32:33], v[32:33], v[48:49]
    v_pk_add_f32 v[34:35], v[34:35], v[50:51]
    v_pk_add_f32 v[36:37], v[36:37], v[52:53]
    v_pk_add_f32 v[38:39], v[38:39], v[54:55]
    v_pk_mul_f32 v[40:41], v[32:33], v[112:113] op_sel_hi:[1,0]
    v_pk_mul_f32 v[42:43], v[34:35], v[112:113] op_sel_hi:[1,0]
    v_pk_mul_f32 v[44:45], v[36:37], v[112:113] op_sel_hi:[1,0]
    v_pk_mul_f32 v[46:47], v[38:39], v[112:113] op_sel_hi:[1,0]
    v_exp_f32 v40, v40
    v_exp_f32 v41, v41
    v_exp_f32 v42, v42
    v_exp_f32 v43, v43
    v_exp_f32 v44, v44
    v_exp_f32 v45, v45
    v_exp_f32 v46, v46
    v_exp_f32 v47, v47
    v_pk_add_f32 v[40:41], v[40:41], v[114:115] op_sel_hi:[1,0]
    v_pk_add_f32 v[42:43], v[42:43], v[114:115] op_sel_hi:[1,0]
    v_pk_add_f32 v[44:45], v[44:45], v[114:115] op_sel_hi:[1,0]
    v_pk_add_f32 v[46:47], v[46:47], v[114:115] op_sel_hi:[1,0]
    v_rcp_f32 v40, v40
    v_rcp_f32 v41, v41
    v_rcp_f32 v42, v42
    v_rcp_f32 v43, v43
    v_rcp_f32 v44, v44
    v_rcp_f32 v45, v45
    v_rcp_f32 v46, v46
    v_rcp_f32 v47, v47
    s_waitcnt lgkmcnt(0)
    v_pk_add_f32 v[64:65], v[64:65], v[72:73]
    v_pk_add_f32 v[66:67], v[66:67], v[74:75]
    v_pk_add_f32 v[68:69], v[68:69], v[76:77]
    v_pk_add_f32 v[70:71], v[70:71], v[78:79]
    v_pk_mul_f32 v[40:41], v[40:41], v[32:33]
    v_pk_mul_f32 v[42:43], v[42:43], v[34:35]
    v_pk_mul_f32 v[44:45], v[44:45], v[36:37]
    v_pk_mul_f32 v[46:47], v[46:47], v[38:39]
    v_pk_fma_f32 v[96:97], v[64:65], v[40:41], v[96:97]
    v_pk_fma_f32 v[98:99], v[66:67], v[42:43], v[98:99]
    v_pk_fma_f32 v[100:101], v[68:69], v[44:45], v[100:101]
    v_pk_fma_f32 v[102:103], v[70:71], v[46:47], v[102:103]
    v_cvt_pk_bf16_f32 v104, v96, v97
    v_cvt_pk_bf16_f32 v105, v98, v99
    v_cvt_pk_bf16_f32 v106, v100, v101
    v_cvt_pk_bf16_f32 v107, v102, v103
    buffer_store_dwordx4 v[104:107], v244, s[28:31], 0 offen sc1
L_fin:
L_end:
    s_endpgm
L_code_end:
.section .rodata,"a"
.p2align 6
.amdhsa_kernel recurrent_scan__sliding_block__dense_activation_silu__prompt_kernel
  .amdhsa_next_free_vgpr 256
  .amdhsa_next_free_sgpr 102
  .amdhsa_accum_offset 256
  .amdhsa_group_segment_fixed_size 0
  .amdhsa_kernarg_size 72
  .amdhsa_user_sgpr_count 2
  .amdhsa_user_sgpr_kernarg_segment_ptr 1
  .amdhsa_system_sgpr_workgroup_id_x 1
.end_amdhsa_kernel
```
